```python
import torch

def _softmax(x, axis=-1):
    return torch.softmax(x, dim=axis)
def _gelu(x):
    return torch.nn.functional.gelu(x, approximate="tanh")
def _silu(x):
    return torch.nn.functional.silu(x)
def _sigmoid(x):
    return torch.sigmoid(x)
def _layernorm(x, axis=-1, eps=1e-5):
    m = x.mean(dim=axis, keepdim=True)
    v = x.var(dim=axis, keepdim=True, unbiased=False)
    return (x - m) / torch.sqrt(v + eps)
def _scatter_add(tgt, idx, src, axis=0):
    return tgt.clone().index_add_(axis, idx, src)
def _segment_sum(src, seg, n):
    out = torch.zeros((n,) + src.shape[1:], dtype=src.dtype)
    return out.index_add_(0, seg, src)
def _pad(x, pw):
    flat = tuple(v for pair in reversed(pw) for v in pair)
    return torch.nn.functional.pad(x, flat)

kernel_name = 'standalone__dense_activation_silu__prompt'

def setup_inputs():

    _w = (lambda a: (lambda t: t.to(torch.bfloat16) if t.is_floating_point() else t)(torch.as_tensor(a)))
    B, S, D, F = 1, 2048, 576, 4608
    return {
        "x": _w((lambda *s: torch.randn(*s, dtype=torch.bfloat16) * 0.1)(B, S, D)),
        "w1": _w((lambda *s: torch.randn(*s, dtype=torch.bfloat16) * 3.2)(D, F) * (D ** -0.5)),
        "w2": _w((lambda *s: torch.randn(*s, dtype=torch.bfloat16) * 3.2)(F, D) * (F ** -0.5)),
    }

def reference(x, w1, w2):
    h = torch.einsum("bsd,df->bsf", x, w1)
    h = _silu(h)
    out = torch.einsum("bsf,fd->bsd", h, w2)
    return out
```

```asm
; @launch grid=(256,1,1) block=(512,1,1) lds=163840
.amdgcn_target "amdgcn-amd-amdhsa--gfx950"
.text
.globl standalone__dense_activation_silu__prompt_kernel
.p2align 8
.type standalone__dense_activation_silu__prompt_kernel,@function
standalone__dense_activation_silu__prompt_kernel:
  s_cmp_ge_u32 s2, 256
  s_cbranch_scc1 L_end
  s_load_dwordx4 s[4:7], s[0:1], 0
  s_load_dwordx4 s[8:11], s[0:1], 16
  s_load_dwordx4 s[12:15], s[0:1], 32
  v_lshrrev_b32 v1, 6, v0
  v_and_b32 v0, 63, v0
  s_and_b32 s47, s2, 7
  v_readfirstlane_b32 s43, v1
  s_getpc_b64 s[52:53]
L_pc:
  s_cmp_ge_u32 s43, 4
  s_cbranch_scc1 L_nocpf
  s_sub_u32 s52, s52, L_pc-standalone__dense_activation_silu__prompt_kernel
  s_subb_u32 s53, s53, 0
  s_lshl_b32 s54, s43, 13
  v_lshlrev_b32 v16, 7, v0
  v_add_u32 v16, s54, v16
  v_min_u32 v16, L_end-standalone__dense_activation_silu__prompt_kernel, v16
  global_load_dword v100, v16, s[52:53]
L_nocpf:
  s_lshr_b32 s48, s2, 3
  s_lshr_b32 s41, s47, 1
  s_and_b32 s49, s47, 1
  s_lshl_b32 s49, s49, 3
  s_and_b32 s45, s48, 7
  s_add_u32 s40, s49, s45
  s_lshr_b32 s42, s48, 3
  s_lshl_b32 s46, s41, 2
  s_add_u32 s46, s46, s42
  s_add_u32 s44, s42, s45
  s_mul_i32 s47, s44, 0x5556
  s_lshr_b32 s47, s47, 16
  s_mul_i32 s47, s47, 3
  s_sub_u32 s44, s44, s47
  s_mul_i32 s44, s44, 3
  s_lshl_b32 s47, s40, 2
  s_add_u32 s47, s47, s41
  s_lshl_b32 s47, s47, 2
  s_add_u32 s47, s47, s42
  s_lshl_b32 s47, s47, 7
  s_add_u32 s96, s47, 67108864
  v_lshlrev_b32 v10, 4, v0
  s_mov_b32 s18, 2359296
  s_mov_b32 s19, 0x20000
  s_mov_b32 s22, 5308416
  s_mov_b32 s23, 0x20000
  s_mov_b32 s26, 5308416
  s_mov_b32 s27, 0x20000
  s_mov_b32 s30, 2359296
  s_mov_b32 s31, 0x20000
  s_mov_b32 s34, 256
  s_mov_b32 s35, 0x20000
  s_mov_b32 s38, 268435456
  s_mov_b32 s39, 0x20000
  s_sub_u32 s50, s43, 4
  v_lshrrev_b32 v23, 3, v0
  v_and_b32 v24, 7, v0
  v_lshrrev_b32 v25, 4, v0
  v_xor_b32 v26, v24, v25
  v_xor_b32 v27, 4, v26
  v_mul_u32_u24 v23, 1152, v23
  v_lshl_add_u32 v2, v26, 4, v23
  v_lshl_add_u32 v3, v27, 4, v23
  s_mov_b32 s52, 0x71c71c8
  s_mov_b32 s53, 0xe38e38f
  s_mov_b32 s54, 9216
  v_add_u32 v23, 0, v0
  v_mul_hi_u32 v24, v23, s52
  v_mul_u32_u24 v25, 36, v24
  v_sub_u32 v25, v23, v25
  v_lshrrev_b32 v26, 2, v24
  v_and_b32 v26, 2, v26
  v_xor_b32 v25, v25, v26
  v_mul_lo_u32 v24, v24, s54
  v_lshl_add_u32 v32, v25, 4, v24
  v_add_u32 v23, 64, v0
  v_mul_hi_u32 v24, v23, s52
  v_mul_u32_u24 v25, 36, v24
  v_sub_u32 v25, v23, v25
  v_lshrrev_b32 v26, 2, v24
  v_and_b32 v26, 2, v26
  v_xor_b32 v25, v25, v26
  v_mul_lo_u32 v24, v24, s54
  v_lshl_add_u32 v33, v25, 4, v24
  v_add_u32 v23, 128, v0
  v_mul_hi_u32 v24, v23, s52
  v_mul_u32_u24 v25, 36, v24
  v_sub_u32 v25, v23, v25
  v_lshrrev_b32 v26, 2, v24
  v_and_b32 v26, 2, v26
  v_xor_b32 v25, v25, v26
  v_mul_lo_u32 v24, v24, s54
  v_lshl_add_u32 v34, v25, 4, v24
  v_add_u32 v23, 192, v0
  v_mul_hi_u32 v24, v23, s52
  v_mul_u32_u24 v25, 36, v24
  v_sub_u32 v25, v23, v25
  v_lshrrev_b32 v26, 2, v24
  v_and_b32 v26, 2, v26
  v_xor_b32 v25, v25, v26
  v_mul_lo_u32 v24, v24, s54
  v_lshl_add_u32 v35, v25, 4, v24
  v_add_u32 v23, 256, v0
  v_mul_hi_u32 v24, v23, s52
  v_mul_u32_u24 v25, 36, v24
  v_sub_u32 v25, v23, v25
  v_lshrrev_b32 v26, 2, v24
  v_and_b32 v26, 2, v26
  v_xor_b32 v25, v25, v26
  v_mul_lo_u32 v24, v24, s54
  v_lshl_add_u32 v36, v25, 4, v24
  v_add_u32 v23, 320, v0
  v_mul_hi_u32 v24, v23, s52
  v_mul_u32_u24 v25, 36, v24
  v_sub_u32 v25, v23, v25
  v_lshrrev_b32 v26, 2, v24
  v_and_b32 v26, 2, v26
  v_xor_b32 v25, v25, v26
  v_mul_lo_u32 v24, v24, s54
  v_lshl_add_u32 v37, v25, 4, v24
  v_add_u32 v23, 384, v0
  v_mul_hi_u32 v24, v23, s52
  v_mul_u32_u24 v25, 36, v24
  v_sub_u32 v25, v23, v25
  v_lshrrev_b32 v26, 2, v24
  v_and_b32 v26, 2, v26
  v_xor_b32 v25, v25, v26
  v_mul_lo_u32 v24, v24, s54
  v_lshl_add_u32 v38, v25, 4, v24
  v_add_u32 v23, 448, v0
  v_mul_hi_u32 v24, v23, s52
  v_mul_u32_u24 v25, 36, v24
  v_sub_u32 v25, v23, v25
  v_lshrrev_b32 v26, 2, v24
  v_and_b32 v26, 2, v26
  v_xor_b32 v25, v25, v26
  v_mul_lo_u32 v24, v24, s54
  v_lshl_add_u32 v39, v25, 4, v24
  v_add_u32 v23, 512, v0
  v_mul_hi_u32 v24, v23, s52
  v_mul_u32_u24 v25, 36, v24
  v_sub_u32 v25, v23, v25
  v_lshrrev_b32 v26, 2, v24
  v_and_b32 v26, 2, v26
  v_xor_b32 v25, v25, v26
  v_mul_lo_u32 v24, v24, s54
  v_lshl_add_u32 v40, v25, 4, v24
  s_mul_i32 s55, s40, 147456
  s_mul_i32 s52, s50, 36864
  s_add_u32 s55, s55, s52
  s_mul_i32 s56, s46, 576
  s_mul_i32 s52, s50, 147456
  s_add_u32 s56, s56, s52
  s_lshl_b32 s57, s44, 7
  s_mul_i32 s58, s44, 589824
  s_lshl_b32 s59, s50, 12
  s_mul_i32 s60, s50, 9216
  s_waitcnt lgkmcnt(0)
  s_mov_b32 s16, s4
  s_and_b32 s17, s5, 0xffff
  s_mov_b32 s20, s6
  s_and_b32 s21, s7, 0xffff
  s_mov_b32 s24, s8
  s_and_b32 s25, s9, 0xffff
  s_mov_b32 s28, s10
  s_and_b32 s29, s11, 0xffff
  s_mov_b32 s32, s12
  s_and_b32 s33, s13, 0xffff
  s_mov_b32 s36, s14
  s_and_b32 s37, s15, 0xffff
  s_cmp_ge_u32 s43, 4
  s_cbranch_scc0 L_compute
L_loader:
  s_add_u32 s61, s55, s57
  s_add_u32 s62, s56, s58
  s_add_u32 m0, s59, 0
  s_add_u32 s63, s61, 0
  buffer_load_dwordx4 v2, s[16:19], s63 offen lds
  s_add_u32 m0, s59, 1024
  s_add_u32 s63, s61, 9216
  buffer_load_dwordx4 v3, s[16:19], s63 offen lds
  s_add_u32 m0, s59, 2048
  s_add_u32 s63, s61, 18432
  buffer_load_dwordx4 v2, s[16:19], s63 offen lds
  s_add_u32 m0, s59, 3072
  s_add_u32 s63, s61, 27648
  buffer_load_dwordx4 v3, s[16:19], s63 offen lds
  s_add_u32 m0, s60, 16384
  s_nop 0
  buffer_load_dwordx4 v32, s[20:23], s62 offen lds
  s_add_u32 m0, s60, 17408
  s_nop 0
  buffer_load_dwordx4 v33, s[20:23], s62 offen lds
  s_add_u32 m0, s60, 18432
  s_nop 0
  buffer_load_dwordx4 v34, s[20:23], s62 offen lds
  s_add_u32 m0, s60, 19456
  s_nop 0
  buffer_load_dwordx4 v35, s[20:23], s62 offen lds
  s_add_u32 m0, s60, 20480
  s_nop 0
  buffer_load_dwordx4 v36, s[20:23], s62 offen lds
  s_add_u32 m0, s60, 21504
  s_nop 0
  buffer_load_dwordx4 v37, s[20:23], s62 offen lds
  s_add_u32 m0, s60, 22528
  s_nop 0
  buffer_load_dwordx4 v38, s[20:23], s62 offen lds
  s_add_u32 m0, s60, 23552
  s_nop 0
  buffer_load_dwordx4 v39, s[20:23], s62 offen lds
  s_add_u32 m0, s60, 24576
  s_nop 0
  buffer_load_dwordx4 v40, s[20:23], s62 offen lds
  s_add_u32 s57, s57, 128
  s_add_u32 s58, s58, 589824
  s_cmp_eq_u32 s57, 1152
  s_cselect_b32 s57, 0, s57
  s_cselect_b32 s58, 0, s58
  v_add_u32 v23, 0, v0
  v_mul_hi_u32 v24, v23, s53
  v_mul_u32_u24 v25, 18, v24
  v_sub_u32 v25, v23, v25
  v_mul_u32_u24 v24, 1152, v24
  v_lshl_add_u32 v41, v25, 4, v24
  v_add_u32 v23, 64, v0
  v_mul_hi_u32 v24, v23, s53
  v_mul_u32_u24 v25, 18, v24
  v_sub_u32 v25, v23, v25
  v_mul_u32_u24 v24, 1152, v24
  v_lshl_add_u32 v42, v25, 4, v24
  v_add_u32 v23, 128, v0
  v_mul_hi_u32 v24, v23, s53
  v_mul_u32_u24 v25, 18, v24
  v_sub_u32 v25, v23, v25
  v_mul_u32_u24 v24, 1152, v24
  v_lshl_add_u32 v43, v25, 4, v24
  v_add_u32 v23, 192, v0
  v_mul_hi_u32 v24, v23, s53
  v_mul_u32_u24 v25, 18, v24
  v_sub_u32 v25, v23, v25
  v_mul_u32_u24 v24, 1152, v24
  v_lshl_add_u32 v44, v25, 4, v24
  v_add_u32 v23, 256, v0
  v_mul_hi_u32 v24, v23, s53
  v_mul_u32_u24 v25, 18, v24
  v_sub_u32 v25, v23, v25
  v_mul_u32_u24 v24, 1152, v24
  v_lshl_add_u32 v45, v25, 4, v24
  v_add_u32 v23, 320, v0
  v_mul_hi_u32 v24, v23, s53
  v_mul_u32_u24 v25, 18, v24
  v_sub_u32 v25, v23, v25
  v_mul_u32_u24 v24, 1152, v24
  v_lshl_add_u32 v46, v25, 4, v24
  v_add_u32 v23, 384, v0
  v_mul_hi_u32 v24, v23, s53
  v_mul_u32_u24 v25, 18, v24
  v_sub_u32 v25, v23, v25
  v_mul_u32_u24 v24, 1152, v24
  v_lshl_add_u32 v47, v25, 4, v24
  v_add_u32 v23, 448, v0
  v_mul_hi_u32 v24, v23, s53
  v_mul_u32_u24 v25, 18, v24
  v_sub_u32 v25, v23, v25
  v_mul_u32_u24 v24, 1152, v24
  v_lshl_add_u32 v48, v25, 4, v24
  v_add_u32 v23, 512, v0
  v_mul_hi_u32 v24, v23, s53
  v_mul_u32_u24 v25, 18, v24
  v_sub_u32 v25, v23, v25
  v_mul_u32_u24 v24, 1152, v24
  v_lshl_add_u32 v49, v25, 4, v24
  s_add_u32 s52, s45, 0
  s_cmp_ge_u32 s52, 9
  s_cselect_b32 s53, 9, 0
  s_sub_u32 s52, s52, s53
  s_mul_i32 s70, s52, 36864
  s_add_u32 s52, s45, 1
  s_cmp_ge_u32 s52, 9
  s_cselect_b32 s53, 9, 0
  s_sub_u32 s52, s52, s53
  s_mul_i32 s71, s52, 36864
  s_add_u32 s52, s45, 2
  s_cmp_ge_u32 s52, 9
  s_cselect_b32 s53, 9, 0
  s_sub_u32 s52, s52, s53
  s_mul_i32 s72, s52, 36864
  s_add_u32 s52, s45, 3
  s_cmp_ge_u32 s52, 9
  s_cselect_b32 s53, 9, 0
  s_sub_u32 s52, s52, s53
  s_mul_i32 s73, s52, 36864
  s_add_u32 s52, s45, 4
  s_cmp_ge_u32 s52, 9
  s_cselect_b32 s53, 9, 0
  s_sub_u32 s52, s52, s53
  s_mul_i32 s74, s52, 36864
  s_add_u32 s52, s45, 5
  s_cmp_ge_u32 s52, 9
  s_cselect_b32 s53, 9, 0
  s_sub_u32 s52, s52, s53
  s_mul_i32 s75, s52, 36864
  s_add_u32 s52, s45, 6
  s_cmp_ge_u32 s52, 9
  s_cselect_b32 s53, 9, 0
  s_sub_u32 s52, s52, s53
  s_mul_i32 s76, s52, 36864
  s_add_u32 s52, s45, 7
  s_cmp_ge_u32 s52, 9
  s_cselect_b32 s53, 9, 0
  s_sub_u32 s52, s52, s53
  s_mul_i32 s77, s52, 36864
  s_add_u32 s52, s45, 8
  s_cmp_ge_u32 s52, 9
  s_cselect_b32 s53, 9, 0
  s_sub_u32 s52, s52, s53
  s_mul_i32 s78, s52, 36864
  s_add_u32 s52, s42, 0
  s_and_b32 s52, s52, 3
  s_lshl_b32 s53, s41, 2
  s_add_u32 s52, s52, s53
  s_mul_i32 s53, s52, 331776
  s_mul_i32 s54, s42, 288
  s_add_u32 s80, s53, s54
  s_add_u32 s52, s42, 1
  s_and_b32 s52, s52, 3
  s_lshl_b32 s53, s41, 2
  s_add_u32 s52, s52, s53
  s_mul_i32 s53, s52, 331776
  s_mul_i32 s54, s42, 288
  s_add_u32 s81, s53, s54
  s_lshl_b32 s53, s40, 4
  s_add_u32 s53, s53, s52
  s_mul_i32 s84, s53, 73728
  s_add_u32 s52, s42, 2
  s_and_b32 s52, s52, 3
  s_lshl_b32 s53, s41, 2
  s_add_u32 s52, s52, s53
  s_mul_i32 s53, s52, 331776
  s_mul_i32 s54, s42, 288
  s_add_u32 s82, s53, s54
  s_lshl_b32 s53, s40, 4
  s_add_u32 s53, s53, s52
  s_mul_i32 s85, s53, 73728
  s_add_u32 s52, s42, 3
  s_and_b32 s52, s52, 3
  s_lshl_b32 s53, s41, 2
  s_add_u32 s52, s52, s53
  s_mul_i32 s53, s52, 331776
  s_mul_i32 s54, s42, 288
  s_add_u32 s83, s53, s54
  s_lshl_b32 s53, s40, 4
  s_add_u32 s53, s53, s52
  s_mul_i32 s86, s53, 73728
  s_waitcnt vmcnt(6)
  s_add_u32 s61, s55, s57
  s_add_u32 s62, s56, s58
  s_add_u32 m0, s59, 53248
  s_add_u32 s63, s61, 0
  buffer_load_dwordx4 v2, s[16:19], s63 offen lds
  s_add_u32 m0, s59, 54272
  s_add_u32 s63, s61, 9216
  buffer_load_dwordx4 v3, s[16:19], s63 offen lds
  s_add_u32 m0, s59, 55296
  s_add_u32 s63, s61, 18432
  buffer_load_dwordx4 v2, s[16:19], s63 offen lds
  s_add_u32 m0, s59, 56320
  s_add_u32 s63, s61, 27648
  buffer_load_dwordx4 v3, s[16:19], s63 offen lds
  s_add_u32 m0, s60, 69632
  s_nop 0
  buffer_load_dwordx4 v32, s[20:23], s62 offen lds
  s_add_u32 m0, s60, 70656
  s_nop 0
  buffer_load_dwordx4 v33, s[20:23], s62 offen lds
  s_add_u32 m0, s60, 71680
  s_nop 0
  buffer_load_dwordx4 v34, s[20:23], s62 offen lds
  s_add_u32 m0, s60, 72704
  s_nop 0
  buffer_load_dwordx4 v35, s[20:23], s62 offen lds
  s_add_u32 m0, s60, 73728
  s_nop 0
  buffer_load_dwordx4 v36, s[20:23], s62 offen lds
  s_add_u32 m0, s60, 74752
  s_nop 0
  buffer_load_dwordx4 v37, s[20:23], s62 offen lds
  s_add_u32 m0, s60, 75776
  s_nop 0
  buffer_load_dwordx4 v38, s[20:23], s62 offen lds
  s_add_u32 m0, s60, 76800
  s_nop 0
  buffer_load_dwordx4 v39, s[20:23], s62 offen lds
  s_add_u32 m0, s60, 77824
  s_nop 0
  buffer_load_dwordx4 v40, s[20:23], s62 offen lds
  s_add_u32 s57, s57, 128
  s_add_u32 s58, s58, 589824
  s_cmp_eq_u32 s57, 1152
  s_cselect_b32 s57, 0, s57
  s_cselect_b32 s58, 0, s58
  s_waitcnt vmcnt(13)
  s_barrier
  s_add_u32 s61, s55, s57
  s_add_u32 s62, s56, s58
  s_add_u32 m0, s59, 106496
  s_add_u32 s63, s61, 0
  buffer_load_dwordx4 v2, s[16:19], s63 offen lds
  s_add_u32 m0, s59, 107520
  s_add_u32 s63, s61, 9216
  buffer_load_dwordx4 v3, s[16:19], s63 offen lds
  s_add_u32 m0, s59, 108544
  s_add_u32 s63, s61, 18432
  buffer_load_dwordx4 v2, s[16:19], s63 offen lds
  s_add_u32 m0, s59, 109568
  s_add_u32 s63, s61, 27648
  buffer_load_dwordx4 v3, s[16:19], s63 offen lds
  s_add_u32 m0, s60, 122880
  s_nop 0
  buffer_load_dwordx4 v32, s[20:23], s62 offen lds
  s_add_u32 m0, s60, 123904
  s_nop 0
  buffer_load_dwordx4 v33, s[20:23], s62 offen lds
  s_add_u32 m0, s60, 124928
  s_nop 0
  buffer_load_dwordx4 v34, s[20:23], s62 offen lds
  s_add_u32 m0, s60, 125952
  s_nop 0
  buffer_load_dwordx4 v35, s[20:23], s62 offen lds
  s_add_u32 m0, s60, 126976
  s_nop 0
  buffer_load_dwordx4 v36, s[20:23], s62 offen lds
  s_add_u32 m0, s60, 128000
  s_nop 0
  buffer_load_dwordx4 v37, s[20:23], s62 offen lds
  s_add_u32 m0, s60, 129024
  s_nop 0
  buffer_load_dwordx4 v38, s[20:23], s62 offen lds
  s_add_u32 m0, s60, 130048
  s_nop 0
  buffer_load_dwordx4 v39, s[20:23], s62 offen lds
  s_add_u32 m0, s60, 131072
  s_nop 0
  buffer_load_dwordx4 v40, s[20:23], s62 offen lds
  s_add_u32 s57, s57, 128
  s_add_u32 s58, s58, 589824
  s_cmp_eq_u32 s57, 1152
  s_cselect_b32 s57, 0, s57
  s_cselect_b32 s58, 0, s58
  s_waitcnt vmcnt(13)
  s_barrier
  s_add_u32 s61, s55, s57
  s_add_u32 s62, s56, s58
  s_add_u32 m0, s59, 0
  s_add_u32 s63, s61, 0
  buffer_load_dwordx4 v2, s[16:19], s63 offen lds
  s_add_u32 m0, s59, 1024
  s_add_u32 s63, s61, 9216
  buffer_load_dwordx4 v3, s[16:19], s63 offen lds
  s_add_u32 m0, s59, 2048
  s_add_u32 s63, s61, 18432
  buffer_load_dwordx4 v2, s[16:19], s63 offen lds
  s_add_u32 m0, s59, 3072
  s_add_u32 s63, s61, 27648
  buffer_load_dwordx4 v3, s[16:19], s63 offen lds
  s_add_u32 m0, s60, 16384
  s_nop 0
  buffer_load_dwordx4 v32, s[20:23], s62 offen lds
  s_add_u32 m0, s60, 17408
  s_nop 0
  buffer_load_dwordx4 v33, s[20:23], s62 offen lds
  s_add_u32 m0, s60, 18432
  s_nop 0
  buffer_load_dwordx4 v34, s[20:23], s62 offen lds
  s_add_u32 m0, s60, 19456
  s_nop 0
  buffer_load_dwordx4 v35, s[20:23], s62 offen lds
  s_add_u32 m0, s60, 20480
  s_nop 0
  buffer_load_dwordx4 v36, s[20:23], s62 offen lds
  s_add_u32 m0, s60, 21504
  s_nop 0
  buffer_load_dwordx4 v37, s[20:23], s62 offen lds
  s_add_u32 m0, s60, 22528
  s_nop 0
  buffer_load_dwordx4 v38, s[20:23], s62 offen lds
  s_add_u32 m0, s60, 23552
  s_nop 0
  buffer_load_dwordx4 v39, s[20:23], s62 offen lds
  s_add_u32 m0, s60, 24576
  s_nop 0
  buffer_load_dwordx4 v40, s[20:23], s62 offen lds
  s_add_u32 s57, s57, 128
  s_add_u32 s58, s58, 589824
  s_cmp_eq_u32 s57, 1152
  s_cselect_b32 s57, 0, s57
  s_cselect_b32 s58, 0, s58
  s_waitcnt vmcnt(13)
  s_barrier
  s_add_u32 s61, s55, s57
  s_add_u32 s62, s56, s58
  s_add_u32 m0, s59, 53248
  s_add_u32 s63, s61, 0
  buffer_load_dwordx4 v2, s[16:19], s63 offen lds
  s_add_u32 m0, s59, 54272
  s_add_u32 s63, s61, 9216
  buffer_load_dwordx4 v3, s[16:19], s63 offen lds
  s_add_u32 m0, s59, 55296
  s_add_u32 s63, s61, 18432
  buffer_load_dwordx4 v2, s[16:19], s63 offen lds
  s_add_u32 m0, s59, 56320
  s_add_u32 s63, s61, 27648
  buffer_load_dwordx4 v3, s[16:19], s63 offen lds
  s_add_u32 m0, s60, 69632
  s_nop 0
  buffer_load_dwordx4 v32, s[20:23], s62 offen lds
  s_add_u32 m0, s60, 70656
  s_nop 0
  buffer_load_dwordx4 v33, s[20:23], s62 offen lds
  s_add_u32 m0, s60, 71680
  s_nop 0
  buffer_load_dwordx4 v34, s[20:23], s62 offen lds
  s_add_u32 m0, s60, 72704
  s_nop 0
  buffer_load_dwordx4 v35, s[20:23], s62 offen lds
  s_add_u32 m0, s60, 73728
  s_nop 0
  buffer_load_dwordx4 v36, s[20:23], s62 offen lds
  s_add_u32 m0, s60, 74752
  s_nop 0
  buffer_load_dwordx4 v37, s[20:23], s62 offen lds
  s_add_u32 m0, s60, 75776
  s_nop 0
  buffer_load_dwordx4 v38, s[20:23], s62 offen lds
  s_add_u32 m0, s60, 76800
  s_nop 0
  buffer_load_dwordx4 v39, s[20:23], s62 offen lds
  s_add_u32 m0, s60, 77824
  s_nop 0
  buffer_load_dwordx4 v40, s[20:23], s62 offen lds
  s_add_u32 s57, s57, 128
  s_add_u32 s58, s58, 589824
  s_cmp_eq_u32 s57, 1152
  s_cselect_b32 s57, 0, s57
  s_cselect_b32 s58, 0, s58
  s_waitcnt vmcnt(13)
  s_barrier
  s_add_u32 s61, s55, s57
  s_add_u32 s62, s56, s58
  s_add_u32 m0, s59, 106496
  s_add_u32 s63, s61, 0
  buffer_load_dwordx4 v2, s[16:19], s63 offen lds
  s_add_u32 m0, s59, 107520
  s_add_u32 s63, s61, 9216
  buffer_load_dwordx4 v3, s[16:19], s63 offen lds
  s_add_u32 m0, s59, 108544
  s_add_u32 s63, s61, 18432
  buffer_load_dwordx4 v2, s[16:19], s63 offen lds
  s_add_u32 m0, s59, 109568
  s_add_u32 s63, s61, 27648
  buffer_load_dwordx4 v3, s[16:19], s63 offen lds
  s_add_u32 m0, s60, 122880
  s_nop 0
  buffer_load_dwordx4 v32, s[20:23], s62 offen lds
  s_add_u32 m0, s60, 123904
  s_nop 0
  buffer_load_dwordx4 v33, s[20:23], s62 offen lds
  s_add_u32 m0, s60, 124928
  s_nop 0
  buffer_load_dwordx4 v34, s[20:23], s62 offen lds
  s_add_u32 m0, s60, 125952
  s_nop 0
  buffer_load_dwordx4 v35, s[20:23], s62 offen lds
  s_add_u32 m0, s60, 126976
  s_nop 0
  buffer_load_dwordx4 v36, s[20:23], s62 offen lds
  s_add_u32 m0, s60, 128000
  s_nop 0
  buffer_load_dwordx4 v37, s[20:23], s62 offen lds
  s_add_u32 m0, s60, 129024
  s_nop 0
  buffer_load_dwordx4 v38, s[20:23], s62 offen lds
  s_add_u32 m0, s60, 130048
  s_nop 0
  buffer_load_dwordx4 v39, s[20:23], s62 offen lds
  s_add_u32 m0, s60, 131072
  s_nop 0
  buffer_load_dwordx4 v40, s[20:23], s62 offen lds
  s_add_u32 s57, s57, 128
  s_add_u32 s58, s58, 589824
  s_cmp_eq_u32 s57, 1152
  s_cselect_b32 s57, 0, s57
  s_cselect_b32 s58, 0, s58
  s_waitcnt vmcnt(13)
  s_barrier
  s_add_u32 s61, s55, s57
  s_add_u32 s62, s56, s58
  s_add_u32 m0, s59, 0
  s_add_u32 s63, s61, 0
  buffer_load_dwordx4 v2, s[16:19], s63 offen lds
  s_add_u32 m0, s59, 1024
  s_add_u32 s63, s61, 9216
  buffer_load_dwordx4 v3, s[16:19], s63 offen lds
  s_add_u32 m0, s59, 2048
  s_add_u32 s63, s61, 18432
  buffer_load_dwordx4 v2, s[16:19], s63 offen lds
  s_add_u32 m0, s59, 3072
  s_add_u32 s63, s61, 27648
  buffer_load_dwordx4 v3, s[16:19], s63 offen lds
  s_add_u32 m0, s60, 16384
  s_nop 0
  buffer_load_dwordx4 v32, s[20:23], s62 offen lds
  s_add_u32 m0, s60, 17408
  s_nop 0
  buffer_load_dwordx4 v33, s[20:23], s62 offen lds
  s_add_u32 m0, s60, 18432
  s_nop 0
  buffer_load_dwordx4 v34, s[20:23], s62 offen lds
  s_add_u32 m0, s60, 19456
  s_nop 0
  buffer_load_dwordx4 v35, s[20:23], s62 offen lds
  s_add_u32 m0, s60, 20480
  s_nop 0
  buffer_load_dwordx4 v36, s[20:23], s62 offen lds
  s_add_u32 m0, s60, 21504
  s_nop 0
  buffer_load_dwordx4 v37, s[20:23], s62 offen lds
  s_add_u32 m0, s60, 22528
  s_nop 0
  buffer_load_dwordx4 v38, s[20:23], s62 offen lds
  s_add_u32 m0, s60, 23552
  s_nop 0
  buffer_load_dwordx4 v39, s[20:23], s62 offen lds
  s_add_u32 m0, s60, 24576
  s_nop 0
  buffer_load_dwordx4 v40, s[20:23], s62 offen lds
  s_add_u32 s57, s57, 128
  s_add_u32 s58, s58, 589824
  s_cmp_eq_u32 s57, 1152
  s_cselect_b32 s57, 0, s57
  s_cselect_b32 s58, 0, s58
  s_waitcnt vmcnt(13)
  s_barrier
  s_add_u32 s61, s55, s57
  s_add_u32 s62, s56, s58
  s_add_u32 m0, s59, 53248
  s_add_u32 s63, s61, 0
  buffer_load_dwordx4 v2, s[16:19], s63 offen lds
  s_add_u32 m0, s59, 54272
  s_add_u32 s63, s61, 9216
  buffer_load_dwordx4 v3, s[16:19], s63 offen lds
  s_add_u32 m0, s59, 55296
  s_add_u32 s63, s61, 18432
  buffer_load_dwordx4 v2, s[16:19], s63 offen lds
  s_add_u32 m0, s59, 56320
  s_add_u32 s63, s61, 27648
  buffer_load_dwordx4 v3, s[16:19], s63 offen lds
  s_add_u32 m0, s60, 69632
  s_nop 0
  buffer_load_dwordx4 v32, s[20:23], s62 offen lds
  s_add_u32 m0, s60, 70656
  s_nop 0
  buffer_load_dwordx4 v33, s[20:23], s62 offen lds
  s_add_u32 m0, s60, 71680
  s_nop 0
  buffer_load_dwordx4 v34, s[20:23], s62 offen lds
  s_add_u32 m0, s60, 72704
  s_nop 0
  buffer_load_dwordx4 v35, s[20:23], s62 offen lds
  s_add_u32 m0, s60, 73728
  s_nop 0
  buffer_load_dwordx4 v36, s[20:23], s62 offen lds
  s_add_u32 m0, s60, 74752
  s_nop 0
  buffer_load_dwordx4 v37, s[20:23], s62 offen lds
  s_add_u32 m0, s60, 75776
  s_nop 0
  buffer_load_dwordx4 v38, s[20:23], s62 offen lds
  s_add_u32 m0, s60, 76800
  s_nop 0
  buffer_load_dwordx4 v39, s[20:23], s62 offen lds
  s_add_u32 m0, s60, 77824
  s_nop 0
  buffer_load_dwordx4 v40, s[20:23], s62 offen lds
  s_add_u32 s57, s57, 128
  s_add_u32 s58, s58, 589824
  s_cmp_eq_u32 s57, 1152
  s_cselect_b32 s57, 0, s57
  s_cselect_b32 s58, 0, s58
  s_waitcnt vmcnt(13)
  s_barrier
  s_add_u32 s61, s55, s57
  s_add_u32 s62, s56, s58
  s_add_u32 m0, s59, 106496
  s_add_u32 s63, s61, 0
  buffer_load_dwordx4 v2, s[16:19], s63 offen lds
  s_add_u32 m0, s59, 107520
  s_add_u32 s63, s61, 9216
  buffer_load_dwordx4 v3, s[16:19], s63 offen lds
  s_add_u32 m0, s59, 108544
  s_add_u32 s63, s61, 18432
  buffer_load_dwordx4 v2, s[16:19], s63 offen lds
  s_add_u32 m0, s59, 109568
  s_add_u32 s63, s61, 27648
  buffer_load_dwordx4 v3, s[16:19], s63 offen lds
  s_add_u32 m0, s60, 122880
  s_nop 0
  buffer_load_dwordx4 v32, s[20:23], s62 offen lds
  s_add_u32 m0, s60, 123904
  s_nop 0
  buffer_load_dwordx4 v33, s[20:23], s62 offen lds
  s_add_u32 m0, s60, 124928
  s_nop 0
  buffer_load_dwordx4 v34, s[20:23], s62 offen lds
  s_add_u32 m0, s60, 125952
  s_nop 0
  buffer_load_dwordx4 v35, s[20:23], s62 offen lds
  s_add_u32 m0, s60, 126976
  s_nop 0
  buffer_load_dwordx4 v36, s[20:23], s62 offen lds
  s_add_u32 m0, s60, 128000
  s_nop 0
  buffer_load_dwordx4 v37, s[20:23], s62 offen lds
  s_add_u32 m0, s60, 129024
  s_nop 0
  buffer_load_dwordx4 v38, s[20:23], s62 offen lds
  s_add_u32 m0, s60, 130048
  s_nop 0
  buffer_load_dwordx4 v39, s[20:23], s62 offen lds
  s_add_u32 m0, s60, 131072
  s_nop 0
  buffer_load_dwordx4 v40, s[20:23], s62 offen lds
  s_add_u32 s57, s57, 128
  s_add_u32 s58, s58, 589824
  s_cmp_eq_u32 s57, 1152
  s_cselect_b32 s57, 0, s57
  s_cselect_b32 s58, 0, s58
  s_waitcnt vmcnt(13)
  s_barrier
  s_cmp_eq_u32 s50, 1
  s_cbranch_scc1 L_ld1
  s_cmp_eq_u32 s50, 2
  s_cbranch_scc1 L_ld2
  s_cmp_eq_u32 s50, 3
  s_cbranch_scc1 L_ld3
  s_add_u32 s61, s80, s70
  s_mov_b32 m0, 0
  s_nop 0
  buffer_load_dwordx4 v41, s[24:27], s61 offen lds
  s_mov_b32 m0, 1024
  s_nop 0
  buffer_load_dwordx4 v42, s[24:27], s61 offen lds
  s_mov_b32 m0, 2048
  s_nop 0
  buffer_load_dwordx4 v43, s[24:27], s61 offen lds
  s_mov_b32 m0, 3072
  s_nop 0
  buffer_load_dwordx4 v44, s[24:27], s61 offen lds
  s_mov_b32 m0, 4096
  s_nop 0
  buffer_load_dwordx4 v45, s[24:27], s61 offen lds
  s_mov_b32 m0, 5120
  s_nop 0
  buffer_load_dwordx4 v46, s[24:27], s61 offen lds
  s_mov_b32 m0, 6144
  s_nop 0
  buffer_load_dwordx4 v47, s[24:27], s61 offen lds
  s_mov_b32 m0, 7168
  s_nop 0
  buffer_load_dwordx4 v48, s[24:27], s61 offen lds
  s_mov_b32 m0, 8192
  s_nop 0
  buffer_load_dwordx4 v49, s[24:27], s61 offen lds
  s_add_u32 s61, s80, s74
  s_mov_b32 m0, 36864
  s_nop 0
  buffer_load_dwordx4 v41, s[24:27], s61 offen lds
  s_mov_b32 m0, 37888
  s_nop 0
  buffer_load_dwordx4 v42, s[24:27], s61 offen lds
  s_mov_b32 m0, 38912
  s_nop 0
  buffer_load_dwordx4 v43, s[24:27], s61 offen lds
  s_mov_b32 m0, 39936
  s_nop 0
  buffer_load_dwordx4 v44, s[24:27], s61 offen lds
  s_mov_b32 m0, 40960
  s_nop 0
  buffer_load_dwordx4 v45, s[24:27], s61 offen lds
  s_mov_b32 m0, 41984
  s_nop 0
  buffer_load_dwordx4 v46, s[24:27], s61 offen lds
  s_mov_b32 m0, 43008
  s_nop 0
  buffer_load_dwordx4 v47, s[24:27], s61 offen lds
  s_mov_b32 m0, 44032
  s_nop 0
  buffer_load_dwordx4 v48, s[24:27], s61 offen lds
  s_mov_b32 m0, 45056
  s_nop 0
  buffer_load_dwordx4 v49, s[24:27], s61 offen lds
  s_waitcnt vmcnt(18)
  s_barrier
  s_add_u32 s61, s80, s78
  s_mov_b32 m0, 73728
  s_nop 0
  buffer_load_dwordx4 v41, s[24:27], s61 offen lds
  s_mov_b32 m0, 74752
  s_nop 0
  buffer_load_dwordx4 v42, s[24:27], s61 offen lds
  s_mov_b32 m0, 75776
  s_nop 0
  buffer_load_dwordx4 v43, s[24:27], s61 offen lds
  s_mov_b32 m0, 76800
  s_nop 0
  buffer_load_dwordx4 v44, s[24:27], s61 offen lds
  s_mov_b32 m0, 77824
  s_nop 0
  buffer_load_dwordx4 v45, s[24:27], s61 offen lds
  s_mov_b32 m0, 78848
  s_nop 0
  buffer_load_dwordx4 v46, s[24:27], s61 offen lds
  s_mov_b32 m0, 79872
  s_nop 0
  buffer_load_dwordx4 v47, s[24:27], s61 offen lds
  s_mov_b32 m0, 80896
  s_nop 0
  buffer_load_dwordx4 v48, s[24:27], s61 offen lds
  s_mov_b32 m0, 81920
  s_nop 0
  buffer_load_dwordx4 v49, s[24:27], s61 offen lds
  s_barrier
  v_and_b32 v25, 15, v0
  v_lshlrev_b32 v25, 2, v25
  s_lshl_b32 s62, s40, 4
  s_mov_b32 s63, 400000
L_poll_init:
  buffer_load_dword v24, v25, s[32:35], s62 offen sc1
  s_waitcnt vmcnt(0)
  v_cmp_le_u32 vcc, 16, v24
  s_sub_u32 s63, s63, 1
  s_cmp_eq_u32 s63, 0
  s_cbranch_scc1 L_polld_init
  s_and_b32 s64, vcc_lo, 1
  s_cmp_eq_u32 s64, 1
  s_cbranch_scc1 L_polld_init
  s_sleep 1
  s_branch L_poll_init
L_polld_init:
  v_lshlrev_b32 v26, 7, v0
  s_andn2_b32 s65, s96, 0x180
  s_lshl_b32 s62, s42, 2
  s_add_u32 s65, s65, s62
  v_mov_b32 v27, 1
  s_barrier
  s_barrier
  s_mov_b64 exec, 0xf
  buffer_store_dword v27, v26, s[36:39], s65 offen sc1
  s_mov_b64 exec, -1
  s_add_u32 s61, s82, s70
  s_mov_b32 m0, 9216
  s_nop 0
  buffer_load_dwordx4 v41, s[24:27], s61 offen lds
  s_mov_b32 m0, 10240
  s_nop 0
  buffer_load_dwordx4 v42, s[24:27], s61 offen lds
  s_mov_b32 m0, 11264
  s_nop 0
  buffer_load_dwordx4 v43, s[24:27], s61 offen lds
  s_mov_b32 m0, 12288
  s_nop 0
  buffer_load_dwordx4 v44, s[24:27], s61 offen lds
  s_mov_b32 m0, 13312
  s_nop 0
  buffer_load_dwordx4 v45, s[24:27], s61 offen lds
  s_mov_b32 m0, 14336
  s_nop 0
  buffer_load_dwordx4 v46, s[24:27], s61 offen lds
  s_mov_b32 m0, 15360
  s_nop 0
  buffer_load_dwordx4 v47, s[24:27], s61 offen lds
  s_mov_b32 m0, 16384
  s_nop 0
  buffer_load_dwordx4 v48, s[24:27], s61 offen lds
  s_mov_b32 m0, 17408
  s_nop 0
  buffer_load_dwordx4 v49, s[24:27], s61 offen lds
  s_barrier
  s_add_u32 s61, s81, s71
  s_mov_b32 m0, 27648
  s_nop 0
  buffer_load_dwordx4 v41, s[24:27], s61 offen lds
  s_mov_b32 m0, 28672
  s_nop 0
  buffer_load_dwordx4 v42, s[24:27], s61 offen lds
  s_mov_b32 m0, 29696
  s_nop 0
  buffer_load_dwordx4 v43, s[24:27], s61 offen lds
  s_mov_b32 m0, 30720
  s_nop 0
  buffer_load_dwordx4 v44, s[24:27], s61 offen lds
  s_mov_b32 m0, 31744
  s_nop 0
  buffer_load_dwordx4 v45, s[24:27], s61 offen lds
  s_mov_b32 m0, 32768
  s_nop 0
  buffer_load_dwordx4 v46, s[24:27], s61 offen lds
  s_mov_b32 m0, 33792
  s_nop 0
  buffer_load_dwordx4 v47, s[24:27], s61 offen lds
  s_mov_b32 m0, 34816
  s_nop 0
  buffer_load_dwordx4 v48, s[24:27], s61 offen lds
  s_mov_b32 m0, 35840
  s_nop 0
  buffer_load_dwordx4 v49, s[24:27], s61 offen lds
  s_barrier
  s_add_u32 s61, s83, s71
  s_mov_b32 m0, 46080
  s_nop 0
  buffer_load_dwordx4 v41, s[24:27], s61 offen lds
  s_mov_b32 m0, 47104
  s_nop 0
  buffer_load_dwordx4 v42, s[24:27], s61 offen lds
  s_mov_b32 m0, 48128
  s_nop 0
  buffer_load_dwordx4 v43, s[24:27], s61 offen lds
  s_mov_b32 m0, 49152
  s_nop 0
  buffer_load_dwordx4 v44, s[24:27], s61 offen lds
  s_mov_b32 m0, 50176
  s_nop 0
  buffer_load_dwordx4 v45, s[24:27], s61 offen lds
  s_mov_b32 m0, 51200
  s_nop 0
  buffer_load_dwordx4 v46, s[24:27], s61 offen lds
  s_mov_b32 m0, 52224
  s_nop 0
  buffer_load_dwordx4 v47, s[24:27], s61 offen lds
  s_mov_b32 m0, 53248
  s_nop 0
  buffer_load_dwordx4 v48, s[24:27], s61 offen lds
  s_mov_b32 m0, 54272
  s_nop 0
  buffer_load_dwordx4 v49, s[24:27], s61 offen lds
  s_barrier
  s_add_u32 s61, s82, s72
  s_mov_b32 m0, 64512
  s_nop 0
  buffer_load_dwordx4 v41, s[24:27], s61 offen lds
  s_mov_b32 m0, 65536
  s_nop 0
  buffer_load_dwordx4 v42, s[24:27], s61 offen lds
  s_mov_b32 m0, 66560
  s_nop 0
  buffer_load_dwordx4 v43, s[24:27], s61 offen lds
  s_mov_b32 m0, 67584
  s_nop 0
  buffer_load_dwordx4 v44, s[24:27], s61 offen lds
  s_mov_b32 m0, 68608
  s_nop 0
  buffer_load_dwordx4 v45, s[24:27], s61 offen lds
  s_mov_b32 m0, 69632
  s_nop 0
  buffer_load_dwordx4 v46, s[24:27], s61 offen lds
  s_mov_b32 m0, 70656
  s_nop 0
  buffer_load_dwordx4 v47, s[24:27], s61 offen lds
  s_mov_b32 m0, 71680
  s_nop 0
  buffer_load_dwordx4 v48, s[24:27], s61 offen lds
  s_mov_b32 m0, 72704
  s_nop 0
  buffer_load_dwordx4 v49, s[24:27], s61 offen lds
  s_waitcnt vmcnt(27)
  s_barrier
  s_add_u32 s61, s81, s73
  s_mov_b32 m0, 0
  s_nop 0
  buffer_load_dwordx4 v41, s[24:27], s61 offen lds
  s_mov_b32 m0, 1024
  s_nop 0
  buffer_load_dwordx4 v42, s[24:27], s61 offen lds
  s_mov_b32 m0, 2048
  s_nop 0
  buffer_load_dwordx4 v43, s[24:27], s61 offen lds
  s_mov_b32 m0, 3072
  s_nop 0
  buffer_load_dwordx4 v44, s[24:27], s61 offen lds
  s_mov_b32 m0, 4096
  s_nop 0
  buffer_load_dwordx4 v45, s[24:27], s61 offen lds
  s_mov_b32 m0, 5120
  s_nop 0
  buffer_load_dwordx4 v46, s[24:27], s61 offen lds
  s_mov_b32 m0, 6144
  s_nop 0
  buffer_load_dwordx4 v47, s[24:27], s61 offen lds
  s_mov_b32 m0, 7168
  s_nop 0
  buffer_load_dwordx4 v48, s[24:27], s61 offen lds
  s_mov_b32 m0, 8192
  s_nop 0
  buffer_load_dwordx4 v49, s[24:27], s61 offen lds
  s_waitcnt vmcnt(27)
  s_barrier
  s_add_u32 s61, s83, s73
  s_mov_b32 m0, 18432
  s_nop 0
  buffer_load_dwordx4 v41, s[24:27], s61 offen lds
  s_mov_b32 m0, 19456
  s_nop 0
  buffer_load_dwordx4 v42, s[24:27], s61 offen lds
  s_mov_b32 m0, 20480
  s_nop 0
  buffer_load_dwordx4 v43, s[24:27], s61 offen lds
  s_mov_b32 m0, 21504
  s_nop 0
  buffer_load_dwordx4 v44, s[24:27], s61 offen lds
  s_mov_b32 m0, 22528
  s_nop 0
  buffer_load_dwordx4 v45, s[24:27], s61 offen lds
  s_mov_b32 m0, 23552
  s_nop 0
  buffer_load_dwordx4 v46, s[24:27], s61 offen lds
  s_mov_b32 m0, 24576
  s_nop 0
  buffer_load_dwordx4 v47, s[24:27], s61 offen lds
  s_mov_b32 m0, 25600
  s_nop 0
  buffer_load_dwordx4 v48, s[24:27], s61 offen lds
  s_mov_b32 m0, 26624
  s_nop 0
  buffer_load_dwordx4 v49, s[24:27], s61 offen lds
  s_waitcnt vmcnt(27)
  s_barrier
  s_add_u32 s61, s82, s74
  s_mov_b32 m0, 36864
  s_nop 0
  buffer_load_dwordx4 v41, s[24:27], s61 offen lds
  s_mov_b32 m0, 37888
  s_nop 0
  buffer_load_dwordx4 v42, s[24:27], s61 offen lds
  s_mov_b32 m0, 38912
  s_nop 0
  buffer_load_dwordx4 v43, s[24:27], s61 offen lds
  s_mov_b32 m0, 39936
  s_nop 0
  buffer_load_dwordx4 v44, s[24:27], s61 offen lds
  s_mov_b32 m0, 40960
  s_nop 0
  buffer_load_dwordx4 v45, s[24:27], s61 offen lds
  s_mov_b32 m0, 41984
  s_nop 0
  buffer_load_dwordx4 v46, s[24:27], s61 offen lds
  s_mov_b32 m0, 43008
  s_nop 0
  buffer_load_dwordx4 v47, s[24:27], s61 offen lds
  s_mov_b32 m0, 44032
  s_nop 0
  buffer_load_dwordx4 v48, s[24:27], s61 offen lds
  s_mov_b32 m0, 45056
  s_nop 0
  buffer_load_dwordx4 v49, s[24:27], s61 offen lds
  s_waitcnt vmcnt(27)
  s_barrier
  s_add_u32 s61, s81, s75
  s_mov_b32 m0, 55296
  s_nop 0
  buffer_load_dwordx4 v41, s[24:27], s61 offen lds
  s_mov_b32 m0, 56320
  s_nop 0
  buffer_load_dwordx4 v42, s[24:27], s61 offen lds
  s_mov_b32 m0, 57344
  s_nop 0
  buffer_load_dwordx4 v43, s[24:27], s61 offen lds
  s_mov_b32 m0, 58368
  s_nop 0
  buffer_load_dwordx4 v44, s[24:27], s61 offen lds
  s_mov_b32 m0, 59392
  s_nop 0
  buffer_load_dwordx4 v45, s[24:27], s61 offen lds
  s_mov_b32 m0, 60416
  s_nop 0
  buffer_load_dwordx4 v46, s[24:27], s61 offen lds
  s_mov_b32 m0, 61440
  s_nop 0
  buffer_load_dwordx4 v47, s[24:27], s61 offen lds
  s_mov_b32 m0, 62464
  s_nop 0
  buffer_load_dwordx4 v48, s[24:27], s61 offen lds
  s_mov_b32 m0, 63488
  s_nop 0
  buffer_load_dwordx4 v49, s[24:27], s61 offen lds
  s_waitcnt vmcnt(27)
  s_barrier
  s_add_u32 s61, s83, s75
  s_mov_b32 m0, 73728
  s_nop 0
  buffer_load_dwordx4 v41, s[24:27], s61 offen lds
  s_mov_b32 m0, 74752
  s_nop 0
  buffer_load_dwordx4 v42, s[24:27], s61 offen lds
  s_mov_b32 m0, 75776
  s_nop 0
  buffer_load_dwordx4 v43, s[24:27], s61 offen lds
  s_mov_b32 m0, 76800
  s_nop 0
  buffer_load_dwordx4 v44, s[24:27], s61 offen lds
  s_mov_b32 m0, 77824
  s_nop 0
  buffer_load_dwordx4 v45, s[24:27], s61 offen lds
  s_mov_b32 m0, 78848
  s_nop 0
  buffer_load_dwordx4 v46, s[24:27], s61 offen lds
  s_mov_b32 m0, 79872
  s_nop 0
  buffer_load_dwordx4 v47, s[24:27], s61 offen lds
  s_mov_b32 m0, 80896
  s_nop 0
  buffer_load_dwordx4 v48, s[24:27], s61 offen lds
  s_mov_b32 m0, 81920
  s_nop 0
  buffer_load_dwordx4 v49, s[24:27], s61 offen lds
  s_waitcnt vmcnt(27)
  s_barrier
  s_add_u32 s61, s82, s76
  s_mov_b32 m0, 9216
  s_nop 0
  buffer_load_dwordx4 v41, s[24:27], s61 offen lds
  s_mov_b32 m0, 10240
  s_nop 0
  buffer_load_dwordx4 v42, s[24:27], s61 offen lds
  s_mov_b32 m0, 11264
  s_nop 0
  buffer_load_dwordx4 v43, s[24:27], s61 offen lds
  s_mov_b32 m0, 12288
  s_nop 0
  buffer_load_dwordx4 v44, s[24:27], s61 offen lds
  s_mov_b32 m0, 13312
  s_nop 0
  buffer_load_dwordx4 v45, s[24:27], s61 offen lds
  s_mov_b32 m0, 14336
  s_nop 0
  buffer_load_dwordx4 v46, s[24:27], s61 offen lds
  s_mov_b32 m0, 15360
  s_nop 0
  buffer_load_dwordx4 v47, s[24:27], s61 offen lds
  s_mov_b32 m0, 16384
  s_nop 0
  buffer_load_dwordx4 v48, s[24:27], s61 offen lds
  s_mov_b32 m0, 17408
  s_nop 0
  buffer_load_dwordx4 v49, s[24:27], s61 offen lds
  s_waitcnt vmcnt(27)
  s_barrier
  s_add_u32 s61, s81, s77
  s_mov_b32 m0, 27648
  s_nop 0
  buffer_load_dwordx4 v41, s[24:27], s61 offen lds
  s_mov_b32 m0, 28672
  s_nop 0
  buffer_load_dwordx4 v42, s[24:27], s61 offen lds
  s_mov_b32 m0, 29696
  s_nop 0
  buffer_load_dwordx4 v43, s[24:27], s61 offen lds
  s_mov_b32 m0, 30720
  s_nop 0
  buffer_load_dwordx4 v44, s[24:27], s61 offen lds
  s_mov_b32 m0, 31744
  s_nop 0
  buffer_load_dwordx4 v45, s[24:27], s61 offen lds
  s_mov_b32 m0, 32768
  s_nop 0
  buffer_load_dwordx4 v46, s[24:27], s61 offen lds
  s_mov_b32 m0, 33792
  s_nop 0
  buffer_load_dwordx4 v47, s[24:27], s61 offen lds
  s_mov_b32 m0, 34816
  s_nop 0
  buffer_load_dwordx4 v48, s[24:27], s61 offen lds
  s_mov_b32 m0, 35840
  s_nop 0
  buffer_load_dwordx4 v49, s[24:27], s61 offen lds
  s_waitcnt vmcnt(27)
  s_barrier
  s_add_u32 s61, s83, s77
  s_mov_b32 m0, 46080
  s_nop 0
  buffer_load_dwordx4 v41, s[24:27], s61 offen lds
  s_mov_b32 m0, 47104
  s_nop 0
  buffer_load_dwordx4 v42, s[24:27], s61 offen lds
  s_mov_b32 m0, 48128
  s_nop 0
  buffer_load_dwordx4 v43, s[24:27], s61 offen lds
  s_mov_b32 m0, 49152
  s_nop 0
  buffer_load_dwordx4 v44, s[24:27], s61 offen lds
  s_mov_b32 m0, 50176
  s_nop 0
  buffer_load_dwordx4 v45, s[24:27], s61 offen lds
  s_mov_b32 m0, 51200
  s_nop 0
  buffer_load_dwordx4 v46, s[24:27], s61 offen lds
  s_mov_b32 m0, 52224
  s_nop 0
  buffer_load_dwordx4 v47, s[24:27], s61 offen lds
  s_mov_b32 m0, 53248
  s_nop 0
  buffer_load_dwordx4 v48, s[24:27], s61 offen lds
  s_mov_b32 m0, 54272
  s_nop 0
  buffer_load_dwordx4 v49, s[24:27], s61 offen lds
  s_waitcnt vmcnt(27)
  s_barrier
  s_add_u32 s61, s82, s78
  s_mov_b32 m0, 64512
  s_nop 0
  buffer_load_dwordx4 v41, s[24:27], s61 offen lds
  s_mov_b32 m0, 65536
  s_nop 0
  buffer_load_dwordx4 v42, s[24:27], s61 offen lds
  s_mov_b32 m0, 66560
  s_nop 0
  buffer_load_dwordx4 v43, s[24:27], s61 offen lds
  s_mov_b32 m0, 67584
  s_nop 0
  buffer_load_dwordx4 v44, s[24:27], s61 offen lds
  s_mov_b32 m0, 68608
  s_nop 0
  buffer_load_dwordx4 v45, s[24:27], s61 offen lds
  s_mov_b32 m0, 69632
  s_nop 0
  buffer_load_dwordx4 v46, s[24:27], s61 offen lds
  s_mov_b32 m0, 70656
  s_nop 0
  buffer_load_dwordx4 v47, s[24:27], s61 offen lds
  s_mov_b32 m0, 71680
  s_nop 0
  buffer_load_dwordx4 v48, s[24:27], s61 offen lds
  s_mov_b32 m0, 72704
  s_nop 0
  buffer_load_dwordx4 v49, s[24:27], s61 offen lds
  s_waitcnt vmcnt(27)
  s_barrier
  s_waitcnt vmcnt(18)
  s_barrier
  s_waitcnt vmcnt(9)
  s_barrier
  s_waitcnt vmcnt(0)
  s_barrier
  s_barrier
  s_barrier
  s_branch L_tail
L_ld1:
  s_add_u32 s61, s80, s71
  s_mov_b32 m0, 9216
  s_nop 0
  buffer_load_dwordx4 v41, s[24:27], s61 offen lds
  s_mov_b32 m0, 10240
  s_nop 0
  buffer_load_dwordx4 v42, s[24:27], s61 offen lds
  s_mov_b32 m0, 11264
  s_nop 0
  buffer_load_dwordx4 v43, s[24:27], s61 offen lds
  s_mov_b32 m0, 12288
  s_nop 0
  buffer_load_dwordx4 v44, s[24:27], s61 offen lds
  s_mov_b32 m0, 13312
  s_nop 0
  buffer_load_dwordx4 v45, s[24:27], s61 offen lds
  s_mov_b32 m0, 14336
  s_nop 0
  buffer_load_dwordx4 v46, s[24:27], s61 offen lds
  s_mov_b32 m0, 15360
  s_nop 0
  buffer_load_dwordx4 v47, s[24:27], s61 offen lds
  s_mov_b32 m0, 16384
  s_nop 0
  buffer_load_dwordx4 v48, s[24:27], s61 offen lds
  s_mov_b32 m0, 17408
  s_nop 0
  buffer_load_dwordx4 v49, s[24:27], s61 offen lds
  s_waitcnt vmcnt(9)
  s_barrier
  s_add_u32 s61, s80, s75
  s_mov_b32 m0, 46080
  s_nop 0
  buffer_load_dwordx4 v41, s[24:27], s61 offen lds
  s_mov_b32 m0, 47104
  s_nop 0
  buffer_load_dwordx4 v42, s[24:27], s61 offen lds
  s_mov_b32 m0, 48128
  s_nop 0
  buffer_load_dwordx4 v43, s[24:27], s61 offen lds
  s_mov_b32 m0, 49152
  s_nop 0
  buffer_load_dwordx4 v44, s[24:27], s61 offen lds
  s_mov_b32 m0, 50176
  s_nop 0
  buffer_load_dwordx4 v45, s[24:27], s61 offen lds
  s_mov_b32 m0, 51200
  s_nop 0
  buffer_load_dwordx4 v46, s[24:27], s61 offen lds
  s_mov_b32 m0, 52224
  s_nop 0
  buffer_load_dwordx4 v47, s[24:27], s61 offen lds
  s_mov_b32 m0, 53248
  s_nop 0
  buffer_load_dwordx4 v48, s[24:27], s61 offen lds
  s_mov_b32 m0, 54272
  s_nop 0
  buffer_load_dwordx4 v49, s[24:27], s61 offen lds
  s_barrier
  v_and_b32 v25, 15, v0
  v_lshlrev_b32 v25, 2, v25
  s_waitcnt vmcnt(9)
  s_barrier
  s_barrier
  s_waitcnt vmcnt(0)
  s_barrier
  s_lshl_b32 s61, 1, s42
  s_xor_b32 s61, s61, 0xf
  s_mov_b32 s63, 400000
L_poll_a1:
  buffer_load_dword v24, v25, s[36:39], s96 offen sc1
  s_waitcnt vmcnt(0)
  v_cmp_le_u32 vcc, 1, v24
  s_sub_u32 s63, s63, 1
  s_cmp_eq_u32 s63, 0
  s_cbranch_scc1 L_polld_a1
  s_and_b32 s64, vcc_lo, s61
  s_cmp_eq_u32 s64, s61
  s_cbranch_scc1 L_polld_a1
  s_sleep 1
  s_branch L_poll_a1
L_polld_a1:
  s_mov_b32 m0, 91136
  s_add_u32 s61, s85, 0
  buffer_load_dwordx4 v10, s[36:39], s61 offen offset:0 lds
  buffer_load_dwordx4 v10, s[36:39], s61 offen offset:1024 lds
  buffer_load_dwordx4 v10, s[36:39], s61 offen offset:2048 lds
  buffer_load_dwordx4 v10, s[36:39], s61 offen offset:3072 lds
  s_mov_b32 m0, 95232
  s_add_u32 s61, s85, 4096
  buffer_load_dwordx4 v10, s[36:39], s61 offen offset:0 lds
  buffer_load_dwordx4 v10, s[36:39], s61 offen offset:1024 lds
  buffer_load_dwordx4 v10, s[36:39], s61 offen offset:2048 lds
  buffer_load_dwordx4 v10, s[36:39], s61 offen offset:3072 lds
  s_mov_b32 m0, 107520
  s_add_u32 s61, s84, 8192
  buffer_load_dwordx4 v10, s[36:39], s61 offen offset:0 lds
  buffer_load_dwordx4 v10, s[36:39], s61 offen offset:1024 lds
  buffer_load_dwordx4 v10, s[36:39], s61 offen offset:2048 lds
  buffer_load_dwordx4 v10, s[36:39], s61 offen offset:3072 lds
  s_mov_b32 m0, 111616
  s_add_u32 s61, s84, 12288
  buffer_load_dwordx4 v10, s[36:39], s61 offen offset:0 lds
  buffer_load_dwordx4 v10, s[36:39], s61 offen offset:1024 lds
  buffer_load_dwordx4 v10, s[36:39], s61 offen offset:2048 lds
  buffer_load_dwordx4 v10, s[36:39], s61 offen offset:3072 lds
  s_barrier
  s_mov_b32 m0, 123904
  s_add_u32 s61, s86, 8192
  buffer_load_dwordx4 v10, s[36:39], s61 offen offset:0 lds
  buffer_load_dwordx4 v10, s[36:39], s61 offen offset:1024 lds
  buffer_load_dwordx4 v10, s[36:39], s61 offen offset:2048 lds
  buffer_load_dwordx4 v10, s[36:39], s61 offen offset:3072 lds
  s_mov_b32 m0, 128000
  s_add_u32 s61, s86, 12288
  buffer_load_dwordx4 v10, s[36:39], s61 offen offset:0 lds
  buffer_load_dwordx4 v10, s[36:39], s61 offen offset:1024 lds
  buffer_load_dwordx4 v10, s[36:39], s61 offen offset:2048 lds
  buffer_load_dwordx4 v10, s[36:39], s61 offen offset:3072 lds
  s_barrier
  s_mov_b32 m0, 140288
  s_add_u32 s61, s85, 16384
  buffer_load_dwordx4 v10, s[36:39], s61 offen offset:0 lds
  buffer_load_dwordx4 v10, s[36:39], s61 offen offset:1024 lds
  buffer_load_dwordx4 v10, s[36:39], s61 offen offset:2048 lds
  buffer_load_dwordx4 v10, s[36:39], s61 offen offset:3072 lds
  s_mov_b32 m0, 144384
  s_add_u32 s61, s85, 20480
  buffer_load_dwordx4 v10, s[36:39], s61 offen offset:0 lds
  buffer_load_dwordx4 v10, s[36:39], s61 offen offset:1024 lds
  buffer_load_dwordx4 v10, s[36:39], s61 offen offset:2048 lds
  buffer_load_dwordx4 v10, s[36:39], s61 offen offset:3072 lds
  s_waitcnt vmcnt(24)
  s_barrier
  s_mov_b32 m0, 82944
  s_add_u32 s61, s84, 24576
  buffer_load_dwordx4 v10, s[36:39], s61 offen offset:0 lds
  buffer_load_dwordx4 v10, s[36:39], s61 offen offset:1024 lds
  buffer_load_dwordx4 v10, s[36:39], s61 offen offset:2048 lds
  buffer_load_dwordx4 v10, s[36:39], s61 offen offset:3072 lds
  s_mov_b32 m0, 87040
  s_add_u32 s61, s84, 28672
  buffer_load_dwordx4 v10, s[36:39], s61 offen offset:0 lds
  buffer_load_dwordx4 v10, s[36:39], s61 offen offset:1024 lds
  buffer_load_dwordx4 v10, s[36:39], s61 offen offset:2048 lds
  buffer_load_dwordx4 v10, s[36:39], s61 offen offset:3072 lds
  s_waitcnt vmcnt(24)
  s_barrier
  s_mov_b32 m0, 99328
  s_add_u32 s61, s86, 24576
  buffer_load_dwordx4 v10, s[36:39], s61 offen offset:0 lds
  buffer_load_dwordx4 v10, s[36:39], s61 offen offset:1024 lds
  buffer_load_dwordx4 v10, s[36:39], s61 offen offset:2048 lds
  buffer_load_dwordx4 v10, s[36:39], s61 offen offset:3072 lds
  s_mov_b32 m0, 103424
  s_add_u32 s61, s86, 28672
  buffer_load_dwordx4 v10, s[36:39], s61 offen offset:0 lds
  buffer_load_dwordx4 v10, s[36:39], s61 offen offset:1024 lds
  buffer_load_dwordx4 v10, s[36:39], s61 offen offset:2048 lds
  buffer_load_dwordx4 v10, s[36:39], s61 offen offset:3072 lds
  s_waitcnt vmcnt(24)
  s_barrier
  s_mov_b32 m0, 115712
  s_add_u32 s61, s85, 32768
  buffer_load_dwordx4 v10, s[36:39], s61 offen offset:0 lds
  buffer_load_dwordx4 v10, s[36:39], s61 offen offset:1024 lds
  buffer_load_dwordx4 v10, s[36:39], s61 offen offset:2048 lds
  buffer_load_dwordx4 v10, s[36:39], s61 offen offset:3072 lds
  s_mov_b32 m0, 119808
  s_add_u32 s61, s85, 36864
  buffer_load_dwordx4 v10, s[36:39], s61 offen offset:0 lds
  buffer_load_dwordx4 v10, s[36:39], s61 offen offset:1024 lds
  buffer_load_dwordx4 v10, s[36:39], s61 offen offset:2048 lds
  buffer_load_dwordx4 v10, s[36:39], s61 offen offset:3072 lds
  s_waitcnt vmcnt(24)
  s_barrier
  s_mov_b32 m0, 132096
  s_add_u32 s61, s84, 40960
  buffer_load_dwordx4 v10, s[36:39], s61 offen offset:0 lds
  buffer_load_dwordx4 v10, s[36:39], s61 offen offset:1024 lds
  buffer_load_dwordx4 v10, s[36:39], s61 offen offset:2048 lds
  buffer_load_dwordx4 v10, s[36:39], s61 offen offset:3072 lds
  s_mov_b32 m0, 136192
  s_add_u32 s61, s84, 45056
  buffer_load_dwordx4 v10, s[36:39], s61 offen offset:0 lds
  buffer_load_dwordx4 v10, s[36:39], s61 offen offset:1024 lds
  buffer_load_dwordx4 v10, s[36:39], s61 offen offset:2048 lds
  buffer_load_dwordx4 v10, s[36:39], s61 offen offset:3072 lds
  s_waitcnt vmcnt(24)
  s_barrier
  s_mov_b32 m0, 148480
  s_add_u32 s61, s86, 40960
  buffer_load_dwordx4 v10, s[36:39], s61 offen offset:0 lds
  buffer_load_dwordx4 v10, s[36:39], s61 offen offset:1024 lds
  buffer_load_dwordx4 v10, s[36:39], s61 offen offset:2048 lds
  buffer_load_dwordx4 v10, s[36:39], s61 offen offset:3072 lds
  s_mov_b32 m0, 152576
  s_add_u32 s61, s86, 45056
  buffer_load_dwordx4 v10, s[36:39], s61 offen offset:0 lds
  buffer_load_dwordx4 v10, s[36:39], s61 offen offset:1024 lds
  buffer_load_dwordx4 v10, s[36:39], s61 offen offset:2048 lds
  buffer_load_dwordx4 v10, s[36:39], s61 offen offset:3072 lds
  s_waitcnt vmcnt(24)
  s_barrier
  s_mov_b32 m0, 91136
  s_add_u32 s61, s85, 49152
  buffer_load_dwordx4 v10, s[36:39], s61 offen offset:0 lds
  buffer_load_dwordx4 v10, s[36:39], s61 offen offset:1024 lds
  buffer_load_dwordx4 v10, s[36:39], s61 offen offset:2048 lds
  buffer_load_dwordx4 v10, s[36:39], s61 offen offset:3072 lds
  s_mov_b32 m0, 95232
  s_add_u32 s61, s85, 53248
  buffer_load_dwordx4 v10, s[36:39], s61 offen offset:0 lds
  buffer_load_dwordx4 v10, s[36:39], s61 offen offset:1024 lds
  buffer_load_dwordx4 v10, s[36:39], s61 offen offset:2048 lds
  buffer_load_dwordx4 v10, s[36:39], s61 offen offset:3072 lds
  s_waitcnt vmcnt(24)
  s_barrier
  s_mov_b32 m0, 107520
  s_add_u32 s61, s84, 57344
  buffer_load_dwordx4 v10, s[36:39], s61 offen offset:0 lds
  buffer_load_dwordx4 v10, s[36:39], s61 offen offset:1024 lds
  buffer_load_dwordx4 v10, s[36:39], s61 offen offset:2048 lds
  buffer_load_dwordx4 v10, s[36:39], s61 offen offset:3072 lds
  s_mov_b32 m0, 111616
  s_add_u32 s61, s84, 61440
  buffer_load_dwordx4 v10, s[36:39], s61 offen offset:0 lds
  buffer_load_dwordx4 v10, s[36:39], s61 offen offset:1024 lds
  buffer_load_dwordx4 v10, s[36:39], s61 offen offset:2048 lds
  buffer_load_dwordx4 v10, s[36:39], s61 offen offset:3072 lds
  s_waitcnt vmcnt(24)
  s_barrier
  s_mov_b32 m0, 123904
  s_add_u32 s61, s86, 57344
  buffer_load_dwordx4 v10, s[36:39], s61 offen offset:0 lds
  buffer_load_dwordx4 v10, s[36:39], s61 offen offset:1024 lds
  buffer_load_dwordx4 v10, s[36:39], s61 offen offset:2048 lds
  buffer_load_dwordx4 v10, s[36:39], s61 offen offset:3072 lds
  s_mov_b32 m0, 128000
  s_add_u32 s61, s86, 61440
  buffer_load_dwordx4 v10, s[36:39], s61 offen offset:0 lds
  buffer_load_dwordx4 v10, s[36:39], s61 offen offset:1024 lds
  buffer_load_dwordx4 v10, s[36:39], s61 offen offset:2048 lds
  buffer_load_dwordx4 v10, s[36:39], s61 offen offset:3072 lds
  s_waitcnt vmcnt(24)
  s_barrier
  s_mov_b32 m0, 140288
  s_add_u32 s61, s85, 65536
  buffer_load_dwordx4 v10, s[36:39], s61 offen offset:0 lds
  buffer_load_dwordx4 v10, s[36:39], s61 offen offset:1024 lds
  buffer_load_dwordx4 v10, s[36:39], s61 offen offset:2048 lds
  buffer_load_dwordx4 v10, s[36:39], s61 offen offset:3072 lds
  s_mov_b32 m0, 144384
  s_add_u32 s61, s85, 69632
  buffer_load_dwordx4 v10, s[36:39], s61 offen offset:0 lds
  buffer_load_dwordx4 v10, s[36:39], s61 offen offset:1024 lds
  buffer_load_dwordx4 v10, s[36:39], s61 offen offset:2048 lds
  buffer_load_dwordx4 v10, s[36:39], s61 offen offset:3072 lds
  s_waitcnt vmcnt(24)
  s_barrier
  s_waitcnt vmcnt(16)
  s_barrier
  s_waitcnt vmcnt(8)
  s_barrier
  s_waitcnt vmcnt(0)
  s_barrier
  s_barrier
  s_barrier
  s_branch L_tail
L_ld2:
  s_add_u32 s61, s80, s72
  s_mov_b32 m0, 18432
  s_nop 0
  buffer_load_dwordx4 v41, s[24:27], s61 offen lds
  s_mov_b32 m0, 19456
  s_nop 0
  buffer_load_dwordx4 v42, s[24:27], s61 offen lds
  s_mov_b32 m0, 20480
  s_nop 0
  buffer_load_dwordx4 v43, s[24:27], s61 offen lds
  s_mov_b32 m0, 21504
  s_nop 0
  buffer_load_dwordx4 v44, s[24:27], s61 offen lds
  s_mov_b32 m0, 22528
  s_nop 0
  buffer_load_dwordx4 v45, s[24:27], s61 offen lds
  s_mov_b32 m0, 23552
  s_nop 0
  buffer_load_dwordx4 v46, s[24:27], s61 offen lds
  s_mov_b32 m0, 24576
  s_nop 0
  buffer_load_dwordx4 v47, s[24:27], s61 offen lds
  s_mov_b32 m0, 25600
  s_nop 0
  buffer_load_dwordx4 v48, s[24:27], s61 offen lds
  s_mov_b32 m0, 26624
  s_nop 0
  buffer_load_dwordx4 v49, s[24:27], s61 offen lds
  s_waitcnt vmcnt(9)
  s_barrier
  s_add_u32 s61, s80, s76
  s_mov_b32 m0, 55296
  s_nop 0
  buffer_load_dwordx4 v41, s[24:27], s61 offen lds
  s_mov_b32 m0, 56320
  s_nop 0
  buffer_load_dwordx4 v42, s[24:27], s61 offen lds
  s_mov_b32 m0, 57344
  s_nop 0
  buffer_load_dwordx4 v43, s[24:27], s61 offen lds
  s_mov_b32 m0, 58368
  s_nop 0
  buffer_load_dwordx4 v44, s[24:27], s61 offen lds
  s_mov_b32 m0, 59392
  s_nop 0
  buffer_load_dwordx4 v45, s[24:27], s61 offen lds
  s_mov_b32 m0, 60416
  s_nop 0
  buffer_load_dwordx4 v46, s[24:27], s61 offen lds
  s_mov_b32 m0, 61440
  s_nop 0
  buffer_load_dwordx4 v47, s[24:27], s61 offen lds
  s_mov_b32 m0, 62464
  s_nop 0
  buffer_load_dwordx4 v48, s[24:27], s61 offen lds
  s_mov_b32 m0, 63488
  s_nop 0
  buffer_load_dwordx4 v49, s[24:27], s61 offen lds
  s_barrier
  s_barrier
  s_waitcnt vmcnt(9)
  s_barrier
  s_add_u32 s61, s81, s70
  s_mov_b32 m0, 0
  s_nop 0
  buffer_load_dwordx4 v41, s[24:27], s61 offen lds
  s_mov_b32 m0, 1024
  s_nop 0
  buffer_load_dwordx4 v42, s[24:27], s61 offen lds
  s_mov_b32 m0, 2048
  s_nop 0
  buffer_load_dwordx4 v43, s[24:27], s61 offen lds
  s_mov_b32 m0, 3072
  s_nop 0
  buffer_load_dwordx4 v44, s[24:27], s61 offen lds
  s_mov_b32 m0, 4096
  s_nop 0
  buffer_load_dwordx4 v45, s[24:27], s61 offen lds
  s_mov_b32 m0, 5120
  s_nop 0
  buffer_load_dwordx4 v46, s[24:27], s61 offen lds
  s_mov_b32 m0, 6144
  s_nop 0
  buffer_load_dwordx4 v47, s[24:27], s61 offen lds
  s_mov_b32 m0, 7168
  s_nop 0
  buffer_load_dwordx4 v48, s[24:27], s61 offen lds
  s_mov_b32 m0, 8192
  s_nop 0
  buffer_load_dwordx4 v49, s[24:27], s61 offen lds
  s_barrier
  s_add_u32 s61, s83, s70
  s_mov_b32 m0, 18432
  s_nop 0
  buffer_load_dwordx4 v41, s[24:27], s61 offen lds
  s_mov_b32 m0, 19456
  s_nop 0
  buffer_load_dwordx4 v42, s[24:27], s61 offen lds
  s_mov_b32 m0, 20480
  s_nop 0
  buffer_load_dwordx4 v43, s[24:27], s61 offen lds
  s_mov_b32 m0, 21504
  s_nop 0
  buffer_load_dwordx4 v44, s[24:27], s61 offen lds
  s_mov_b32 m0, 22528
  s_nop 0
  buffer_load_dwordx4 v45, s[24:27], s61 offen lds
  s_mov_b32 m0, 23552
  s_nop 0
  buffer_load_dwordx4 v46, s[24:27], s61 offen lds
  s_mov_b32 m0, 24576
  s_nop 0
  buffer_load_dwordx4 v47, s[24:27], s61 offen lds
  s_mov_b32 m0, 25600
  s_nop 0
  buffer_load_dwordx4 v48, s[24:27], s61 offen lds
  s_mov_b32 m0, 26624
  s_nop 0
  buffer_load_dwordx4 v49, s[24:27], s61 offen lds
  s_waitcnt vmcnt(18)
  s_barrier
  s_add_u32 s61, s82, s71
  s_mov_b32 m0, 36864
  s_nop 0
  buffer_load_dwordx4 v41, s[24:27], s61 offen lds
  s_mov_b32 m0, 37888
  s_nop 0
  buffer_load_dwordx4 v42, s[24:27], s61 offen lds
  s_mov_b32 m0, 38912
  s_nop 0
  buffer_load_dwordx4 v43, s[24:27], s61 offen lds
  s_mov_b32 m0, 39936
  s_nop 0
  buffer_load_dwordx4 v44, s[24:27], s61 offen lds
  s_mov_b32 m0, 40960
  s_nop 0
  buffer_load_dwordx4 v45, s[24:27], s61 offen lds
  s_mov_b32 m0, 41984
  s_nop 0
  buffer_load_dwordx4 v46, s[24:27], s61 offen lds
  s_mov_b32 m0, 43008
  s_nop 0
  buffer_load_dwordx4 v47, s[24:27], s61 offen lds
  s_mov_b32 m0, 44032
  s_nop 0
  buffer_load_dwordx4 v48, s[24:27], s61 offen lds
  s_mov_b32 m0, 45056
  s_nop 0
  buffer_load_dwordx4 v49, s[24:27], s61 offen lds
  s_waitcnt vmcnt(18)
  s_barrier
  s_add_u32 s61, s81, s72
  s_mov_b32 m0, 55296
  s_nop 0
  buffer_load_dwordx4 v41, s[24:27], s61 offen lds
  s_mov_b32 m0, 56320
  s_nop 0
  buffer_load_dwordx4 v42, s[24:27], s61 offen lds
  s_mov_b32 m0, 57344
  s_nop 0
  buffer_load_dwordx4 v43, s[24:27], s61 offen lds
  s_mov_b32 m0, 58368
  s_nop 0
  buffer_load_dwordx4 v44, s[24:27], s61 offen lds
  s_mov_b32 m0, 59392
  s_nop 0
  buffer_load_dwordx4 v45, s[24:27], s61 offen lds
  s_mov_b32 m0, 60416
  s_nop 0
  buffer_load_dwordx4 v46, s[24:27], s61 offen lds
  s_mov_b32 m0, 61440
  s_nop 0
  buffer_load_dwordx4 v47, s[24:27], s61 offen lds
  s_mov_b32 m0, 62464
  s_nop 0
  buffer_load_dwordx4 v48, s[24:27], s61 offen lds
  s_mov_b32 m0, 63488
  s_nop 0
  buffer_load_dwordx4 v49, s[24:27], s61 offen lds
  s_waitcnt vmcnt(18)
  s_barrier
  s_add_u32 s61, s83, s72
  s_mov_b32 m0, 73728
  s_nop 0
  buffer_load_dwordx4 v41, s[24:27], s61 offen lds
  s_mov_b32 m0, 74752
  s_nop 0
  buffer_load_dwordx4 v42, s[24:27], s61 offen lds
  s_mov_b32 m0, 75776
  s_nop 0
  buffer_load_dwordx4 v43, s[24:27], s61 offen lds
  s_mov_b32 m0, 76800
  s_nop 0
  buffer_load_dwordx4 v44, s[24:27], s61 offen lds
  s_mov_b32 m0, 77824
  s_nop 0
  buffer_load_dwordx4 v45, s[24:27], s61 offen lds
  s_mov_b32 m0, 78848
  s_nop 0
  buffer_load_dwordx4 v46, s[24:27], s61 offen lds
  s_mov_b32 m0, 79872
  s_nop 0
  buffer_load_dwordx4 v47, s[24:27], s61 offen lds
  s_mov_b32 m0, 80896
  s_nop 0
  buffer_load_dwordx4 v48, s[24:27], s61 offen lds
  s_mov_b32 m0, 81920
  s_nop 0
  buffer_load_dwordx4 v49, s[24:27], s61 offen lds
  s_waitcnt vmcnt(18)
  s_barrier
  s_add_u32 s61, s82, s73
  s_mov_b32 m0, 9216
  s_nop 0
  buffer_load_dwordx4 v41, s[24:27], s61 offen lds
  s_mov_b32 m0, 10240
  s_nop 0
  buffer_load_dwordx4 v42, s[24:27], s61 offen lds
  s_mov_b32 m0, 11264
  s_nop 0
  buffer_load_dwordx4 v43, s[24:27], s61 offen lds
  s_mov_b32 m0, 12288
  s_nop 0
  buffer_load_dwordx4 v44, s[24:27], s61 offen lds
  s_mov_b32 m0, 13312
  s_nop 0
  buffer_load_dwordx4 v45, s[24:27], s61 offen lds
  s_mov_b32 m0, 14336
  s_nop 0
  buffer_load_dwordx4 v46, s[24:27], s61 offen lds
  s_mov_b32 m0, 15360
  s_nop 0
  buffer_load_dwordx4 v47, s[24:27], s61 offen lds
  s_mov_b32 m0, 16384
  s_nop 0
  buffer_load_dwordx4 v48, s[24:27], s61 offen lds
  s_mov_b32 m0, 17408
  s_nop 0
  buffer_load_dwordx4 v49, s[24:27], s61 offen lds
  s_waitcnt vmcnt(18)
  s_barrier
  s_add_u32 s61, s81, s74
  s_mov_b32 m0, 27648
  s_nop 0
  buffer_load_dwordx4 v41, s[24:27], s61 offen lds
  s_mov_b32 m0, 28672
  s_nop 0
  buffer_load_dwordx4 v42, s[24:27], s61 offen lds
  s_mov_b32 m0, 29696
  s_nop 0
  buffer_load_dwordx4 v43, s[24:27], s61 offen lds
  s_mov_b32 m0, 30720
  s_nop 0
  buffer_load_dwordx4 v44, s[24:27], s61 offen lds
  s_mov_b32 m0, 31744
  s_nop 0
  buffer_load_dwordx4 v45, s[24:27], s61 offen lds
  s_mov_b32 m0, 32768
  s_nop 0
  buffer_load_dwordx4 v46, s[24:27], s61 offen lds
  s_mov_b32 m0, 33792
  s_nop 0
  buffer_load_dwordx4 v47, s[24:27], s61 offen lds
  s_mov_b32 m0, 34816
  s_nop 0
  buffer_load_dwordx4 v48, s[24:27], s61 offen lds
  s_mov_b32 m0, 35840
  s_nop 0
  buffer_load_dwordx4 v49, s[24:27], s61 offen lds
  s_waitcnt vmcnt(18)
  s_barrier
  s_add_u32 s61, s83, s74
  s_mov_b32 m0, 46080
  s_nop 0
  buffer_load_dwordx4 v41, s[24:27], s61 offen lds
  s_mov_b32 m0, 47104
  s_nop 0
  buffer_load_dwordx4 v42, s[24:27], s61 offen lds
  s_mov_b32 m0, 48128
  s_nop 0
  buffer_load_dwordx4 v43, s[24:27], s61 offen lds
  s_mov_b32 m0, 49152
  s_nop 0
  buffer_load_dwordx4 v44, s[24:27], s61 offen lds
  s_mov_b32 m0, 50176
  s_nop 0
  buffer_load_dwordx4 v45, s[24:27], s61 offen lds
  s_mov_b32 m0, 51200
  s_nop 0
  buffer_load_dwordx4 v46, s[24:27], s61 offen lds
  s_mov_b32 m0, 52224
  s_nop 0
  buffer_load_dwordx4 v47, s[24:27], s61 offen lds
  s_mov_b32 m0, 53248
  s_nop 0
  buffer_load_dwordx4 v48, s[24:27], s61 offen lds
  s_mov_b32 m0, 54272
  s_nop 0
  buffer_load_dwordx4 v49, s[24:27], s61 offen lds
  s_waitcnt vmcnt(18)
  s_barrier
  s_add_u32 s61, s82, s75
  s_mov_b32 m0, 64512
  s_nop 0
  buffer_load_dwordx4 v41, s[24:27], s61 offen lds
  s_mov_b32 m0, 65536
  s_nop 0
  buffer_load_dwordx4 v42, s[24:27], s61 offen lds
  s_mov_b32 m0, 66560
  s_nop 0
  buffer_load_dwordx4 v43, s[24:27], s61 offen lds
  s_mov_b32 m0, 67584
  s_nop 0
  buffer_load_dwordx4 v44, s[24:27], s61 offen lds
  s_mov_b32 m0, 68608
  s_nop 0
  buffer_load_dwordx4 v45, s[24:27], s61 offen lds
  s_mov_b32 m0, 69632
  s_nop 0
  buffer_load_dwordx4 v46, s[24:27], s61 offen lds
  s_mov_b32 m0, 70656
  s_nop 0
  buffer_load_dwordx4 v47, s[24:27], s61 offen lds
  s_mov_b32 m0, 71680
  s_nop 0
  buffer_load_dwordx4 v48, s[24:27], s61 offen lds
  s_mov_b32 m0, 72704
  s_nop 0
  buffer_load_dwordx4 v49, s[24:27], s61 offen lds
  s_waitcnt vmcnt(18)
  s_barrier
  s_add_u32 s61, s81, s76
  s_mov_b32 m0, 0
  s_nop 0
  buffer_load_dwordx4 v41, s[24:27], s61 offen lds
  s_mov_b32 m0, 1024
  s_nop 0
  buffer_load_dwordx4 v42, s[24:27], s61 offen lds
  s_mov_b32 m0, 2048
  s_nop 0
  buffer_load_dwordx4 v43, s[24:27], s61 offen lds
  s_mov_b32 m0, 3072
  s_nop 0
  buffer_load_dwordx4 v44, s[24:27], s61 offen lds
  s_mov_b32 m0, 4096
  s_nop 0
  buffer_load_dwordx4 v45, s[24:27], s61 offen lds
  s_mov_b32 m0, 5120
  s_nop 0
  buffer_load_dwordx4 v46, s[24:27], s61 offen lds
  s_mov_b32 m0, 6144
  s_nop 0
  buffer_load_dwordx4 v47, s[24:27], s61 offen lds
  s_mov_b32 m0, 7168
  s_nop 0
  buffer_load_dwordx4 v48, s[24:27], s61 offen lds
  s_mov_b32 m0, 8192
  s_nop 0
  buffer_load_dwordx4 v49, s[24:27], s61 offen lds
  s_waitcnt vmcnt(18)
  s_barrier
  s_add_u32 s61, s83, s76
  s_mov_b32 m0, 18432
  s_nop 0
  buffer_load_dwordx4 v41, s[24:27], s61 offen lds
  s_mov_b32 m0, 19456
  s_nop 0
  buffer_load_dwordx4 v42, s[24:27], s61 offen lds
  s_mov_b32 m0, 20480
  s_nop 0
  buffer_load_dwordx4 v43, s[24:27], s61 offen lds
  s_mov_b32 m0, 21504
  s_nop 0
  buffer_load_dwordx4 v44, s[24:27], s61 offen lds
  s_mov_b32 m0, 22528
  s_nop 0
  buffer_load_dwordx4 v45, s[24:27], s61 offen lds
  s_mov_b32 m0, 23552
  s_nop 0
  buffer_load_dwordx4 v46, s[24:27], s61 offen lds
  s_mov_b32 m0, 24576
  s_nop 0
  buffer_load_dwordx4 v47, s[24:27], s61 offen lds
  s_mov_b32 m0, 25600
  s_nop 0
  buffer_load_dwordx4 v48, s[24:27], s61 offen lds
  s_mov_b32 m0, 26624
  s_nop 0
  buffer_load_dwordx4 v49, s[24:27], s61 offen lds
  s_waitcnt vmcnt(18)
  s_barrier
  s_add_u32 s61, s82, s77
  s_mov_b32 m0, 36864
  s_nop 0
  buffer_load_dwordx4 v41, s[24:27], s61 offen lds
  s_mov_b32 m0, 37888
  s_nop 0
  buffer_load_dwordx4 v42, s[24:27], s61 offen lds
  s_mov_b32 m0, 38912
  s_nop 0
  buffer_load_dwordx4 v43, s[24:27], s61 offen lds
  s_mov_b32 m0, 39936
  s_nop 0
  buffer_load_dwordx4 v44, s[24:27], s61 offen lds
  s_mov_b32 m0, 40960
  s_nop 0
  buffer_load_dwordx4 v45, s[24:27], s61 offen lds
  s_mov_b32 m0, 41984
  s_nop 0
  buffer_load_dwordx4 v46, s[24:27], s61 offen lds
  s_mov_b32 m0, 43008
  s_nop 0
  buffer_load_dwordx4 v47, s[24:27], s61 offen lds
  s_mov_b32 m0, 44032
  s_nop 0
  buffer_load_dwordx4 v48, s[24:27], s61 offen lds
  s_mov_b32 m0, 45056
  s_nop 0
  buffer_load_dwordx4 v49, s[24:27], s61 offen lds
  s_waitcnt vmcnt(18)
  s_barrier
  s_add_u32 s61, s81, s78
  s_mov_b32 m0, 55296
  s_nop 0
  buffer_load_dwordx4 v41, s[24:27], s61 offen lds
  s_mov_b32 m0, 56320
  s_nop 0
  buffer_load_dwordx4 v42, s[24:27], s61 offen lds
  s_mov_b32 m0, 57344
  s_nop 0
  buffer_load_dwordx4 v43, s[24:27], s61 offen lds
  s_mov_b32 m0, 58368
  s_nop 0
  buffer_load_dwordx4 v44, s[24:27], s61 offen lds
  s_mov_b32 m0, 59392
  s_nop 0
  buffer_load_dwordx4 v45, s[24:27], s61 offen lds
  s_mov_b32 m0, 60416
  s_nop 0
  buffer_load_dwordx4 v46, s[24:27], s61 offen lds
  s_mov_b32 m0, 61440
  s_nop 0
  buffer_load_dwordx4 v47, s[24:27], s61 offen lds
  s_mov_b32 m0, 62464
  s_nop 0
  buffer_load_dwordx4 v48, s[24:27], s61 offen lds
  s_mov_b32 m0, 63488
  s_nop 0
  buffer_load_dwordx4 v49, s[24:27], s61 offen lds
  s_waitcnt vmcnt(18)
  s_barrier
  s_add_u32 s61, s83, s78
  s_mov_b32 m0, 73728
  s_nop 0
  buffer_load_dwordx4 v41, s[24:27], s61 offen lds
  s_mov_b32 m0, 74752
  s_nop 0
  buffer_load_dwordx4 v42, s[24:27], s61 offen lds
  s_mov_b32 m0, 75776
  s_nop 0
  buffer_load_dwordx4 v43, s[24:27], s61 offen lds
  s_mov_b32 m0, 76800
  s_nop 0
  buffer_load_dwordx4 v44, s[24:27], s61 offen lds
  s_mov_b32 m0, 77824
  s_nop 0
  buffer_load_dwordx4 v45, s[24:27], s61 offen lds
  s_mov_b32 m0, 78848
  s_nop 0
  buffer_load_dwordx4 v46, s[24:27], s61 offen lds
  s_mov_b32 m0, 79872
  s_nop 0
  buffer_load_dwordx4 v47, s[24:27], s61 offen lds
  s_mov_b32 m0, 80896
  s_nop 0
  buffer_load_dwordx4 v48, s[24:27], s61 offen lds
  s_mov_b32 m0, 81920
  s_nop 0
  buffer_load_dwordx4 v49, s[24:27], s61 offen lds
  s_waitcnt vmcnt(18)
  s_barrier
  s_waitcnt vmcnt(9)
  s_barrier
  s_waitcnt vmcnt(0)
  s_barrier
  s_barrier
  s_barrier
  s_branch L_tail
L_ld3:
  s_add_u32 s61, s80, s73
  s_mov_b32 m0, 27648
  s_nop 0
  buffer_load_dwordx4 v41, s[24:27], s61 offen lds
  s_mov_b32 m0, 28672
  s_nop 0
  buffer_load_dwordx4 v42, s[24:27], s61 offen lds
  s_mov_b32 m0, 29696
  s_nop 0
  buffer_load_dwordx4 v43, s[24:27], s61 offen lds
  s_mov_b32 m0, 30720
  s_nop 0
  buffer_load_dwordx4 v44, s[24:27], s61 offen lds
  s_mov_b32 m0, 31744
  s_nop 0
  buffer_load_dwordx4 v45, s[24:27], s61 offen lds
  s_mov_b32 m0, 32768
  s_nop 0
  buffer_load_dwordx4 v46, s[24:27], s61 offen lds
  s_mov_b32 m0, 33792
  s_nop 0
  buffer_load_dwordx4 v47, s[24:27], s61 offen lds
  s_mov_b32 m0, 34816
  s_nop 0
  buffer_load_dwordx4 v48, s[24:27], s61 offen lds
  s_mov_b32 m0, 35840
  s_nop 0
  buffer_load_dwordx4 v49, s[24:27], s61 offen lds
  s_waitcnt vmcnt(9)
  s_barrier
  s_add_u32 s61, s80, s77
  s_mov_b32 m0, 64512
  s_nop 0
  buffer_load_dwordx4 v41, s[24:27], s61 offen lds
  s_mov_b32 m0, 65536
  s_nop 0
  buffer_load_dwordx4 v42, s[24:27], s61 offen lds
  s_mov_b32 m0, 66560
  s_nop 0
  buffer_load_dwordx4 v43, s[24:27], s61 offen lds
  s_mov_b32 m0, 67584
  s_nop 0
  buffer_load_dwordx4 v44, s[24:27], s61 offen lds
  s_mov_b32 m0, 68608
  s_nop 0
  buffer_load_dwordx4 v45, s[24:27], s61 offen lds
  s_mov_b32 m0, 69632
  s_nop 0
  buffer_load_dwordx4 v46, s[24:27], s61 offen lds
  s_mov_b32 m0, 70656
  s_nop 0
  buffer_load_dwordx4 v47, s[24:27], s61 offen lds
  s_mov_b32 m0, 71680
  s_nop 0
  buffer_load_dwordx4 v48, s[24:27], s61 offen lds
  s_mov_b32 m0, 72704
  s_nop 0
  buffer_load_dwordx4 v49, s[24:27], s61 offen lds
  s_barrier
  v_and_b32 v25, 15, v0
  v_lshlrev_b32 v25, 2, v25
  s_barrier
  s_waitcnt vmcnt(9)
  s_barrier
  s_barrier
  s_lshl_b32 s61, 1, s42
  s_xor_b32 s61, s61, 0xf
  s_mov_b32 s63, 400000
L_poll_a3:
  buffer_load_dword v24, v25, s[36:39], s96 offen sc1
  s_waitcnt vmcnt(0)
  v_cmp_le_u32 vcc, 1, v24
  s_sub_u32 s63, s63, 1
  s_cmp_eq_u32 s63, 0
  s_cbranch_scc1 L_polld_a3
  s_and_b32 s64, vcc_lo, s61
  s_cmp_eq_u32 s64, s61
  s_cbranch_scc1 L_polld_a3
  s_sleep 1
  s_branch L_poll_a3
L_polld_a3:
  s_mov_b32 m0, 82944
  s_add_u32 s61, s84, 0
  buffer_load_dwordx4 v10, s[36:39], s61 offen offset:0 lds
  buffer_load_dwordx4 v10, s[36:39], s61 offen offset:1024 lds
  buffer_load_dwordx4 v10, s[36:39], s61 offen offset:2048 lds
  buffer_load_dwordx4 v10, s[36:39], s61 offen offset:3072 lds
  s_mov_b32 m0, 87040
  s_add_u32 s61, s84, 4096
  buffer_load_dwordx4 v10, s[36:39], s61 offen offset:0 lds
  buffer_load_dwordx4 v10, s[36:39], s61 offen offset:1024 lds
  buffer_load_dwordx4 v10, s[36:39], s61 offen offset:2048 lds
  buffer_load_dwordx4 v10, s[36:39], s61 offen offset:3072 lds
  s_mov_b32 m0, 99328
  s_add_u32 s61, s86, 0
  buffer_load_dwordx4 v10, s[36:39], s61 offen offset:0 lds
  buffer_load_dwordx4 v10, s[36:39], s61 offen offset:1024 lds
  buffer_load_dwordx4 v10, s[36:39], s61 offen offset:2048 lds
  buffer_load_dwordx4 v10, s[36:39], s61 offen offset:3072 lds
  s_mov_b32 m0, 103424
  s_add_u32 s61, s86, 4096
  buffer_load_dwordx4 v10, s[36:39], s61 offen offset:0 lds
  buffer_load_dwordx4 v10, s[36:39], s61 offen offset:1024 lds
  buffer_load_dwordx4 v10, s[36:39], s61 offen offset:2048 lds
  buffer_load_dwordx4 v10, s[36:39], s61 offen offset:3072 lds
  s_barrier
  s_mov_b32 m0, 115712
  s_add_u32 s61, s85, 8192
  buffer_load_dwordx4 v10, s[36:39], s61 offen offset:0 lds
  buffer_load_dwordx4 v10, s[36:39], s61 offen offset:1024 lds
  buffer_load_dwordx4 v10, s[36:39], s61 offen offset:2048 lds
  buffer_load_dwordx4 v10, s[36:39], s61 offen offset:3072 lds
  s_mov_b32 m0, 119808
  s_add_u32 s61, s85, 12288
  buffer_load_dwordx4 v10, s[36:39], s61 offen offset:0 lds
  buffer_load_dwordx4 v10, s[36:39], s61 offen offset:1024 lds
  buffer_load_dwordx4 v10, s[36:39], s61 offen offset:2048 lds
  buffer_load_dwordx4 v10, s[36:39], s61 offen offset:3072 lds
  s_waitcnt vmcnt(16)
  s_barrier
  s_mov_b32 m0, 132096
  s_add_u32 s61, s84, 16384
  buffer_load_dwordx4 v10, s[36:39], s61 offen offset:0 lds
  buffer_load_dwordx4 v10, s[36:39], s61 offen offset:1024 lds
  buffer_load_dwordx4 v10, s[36:39], s61 offen offset:2048 lds
  buffer_load_dwordx4 v10, s[36:39], s61 offen offset:3072 lds
  s_mov_b32 m0, 136192
  s_add_u32 s61, s84, 20480
  buffer_load_dwordx4 v10, s[36:39], s61 offen offset:0 lds
  buffer_load_dwordx4 v10, s[36:39], s61 offen offset:1024 lds
  buffer_load_dwordx4 v10, s[36:39], s61 offen offset:2048 lds
  buffer_load_dwordx4 v10, s[36:39], s61 offen offset:3072 lds
  s_waitcnt vmcnt(16)
  s_barrier
  s_mov_b32 m0, 148480
  s_add_u32 s61, s86, 16384
  buffer_load_dwordx4 v10, s[36:39], s61 offen offset:0 lds
  buffer_load_dwordx4 v10, s[36:39], s61 offen offset:1024 lds
  buffer_load_dwordx4 v10, s[36:39], s61 offen offset:2048 lds
  buffer_load_dwordx4 v10, s[36:39], s61 offen offset:3072 lds
  s_mov_b32 m0, 152576
  s_add_u32 s61, s86, 20480
  buffer_load_dwordx4 v10, s[36:39], s61 offen offset:0 lds
  buffer_load_dwordx4 v10, s[36:39], s61 offen offset:1024 lds
  buffer_load_dwordx4 v10, s[36:39], s61 offen offset:2048 lds
  buffer_load_dwordx4 v10, s[36:39], s61 offen offset:3072 lds
  s_waitcnt vmcnt(16)
  s_barrier
  s_mov_b32 m0, 91136
  s_add_u32 s61, s85, 24576
  buffer_load_dwordx4 v10, s[36:39], s61 offen offset:0 lds
  buffer_load_dwordx4 v10, s[36:39], s61 offen offset:1024 lds
  buffer_load_dwordx4 v10, s[36:39], s61 offen offset:2048 lds
  buffer_load_dwordx4 v10, s[36:39], s61 offen offset:3072 lds
  s_mov_b32 m0, 95232
  s_add_u32 s61, s85, 28672
  buffer_load_dwordx4 v10, s[36:39], s61 offen offset:0 lds
  buffer_load_dwordx4 v10, s[36:39], s61 offen offset:1024 lds
  buffer_load_dwordx4 v10, s[36:39], s61 offen offset:2048 lds
  buffer_load_dwordx4 v10, s[36:39], s61 offen offset:3072 lds
  s_waitcnt vmcnt(16)
  s_barrier
  s_mov_b32 m0, 107520
  s_add_u32 s61, s84, 32768
  buffer_load_dwordx4 v10, s[36:39], s61 offen offset:0 lds
  buffer_load_dwordx4 v10, s[36:39], s61 offen offset:1024 lds
  buffer_load_dwordx4 v10, s[36:39], s61 offen offset:2048 lds
  buffer_load_dwordx4 v10, s[36:39], s61 offen offset:3072 lds
  s_mov_b32 m0, 111616
  s_add_u32 s61, s84, 36864
  buffer_load_dwordx4 v10, s[36:39], s61 offen offset:0 lds
  buffer_load_dwordx4 v10, s[36:39], s61 offen offset:1024 lds
  buffer_load_dwordx4 v10, s[36:39], s61 offen offset:2048 lds
  buffer_load_dwordx4 v10, s[36:39], s61 offen offset:3072 lds
  s_waitcnt vmcnt(16)
  s_barrier
  s_mov_b32 m0, 123904
  s_add_u32 s61, s86, 32768
  buffer_load_dwordx4 v10, s[36:39], s61 offen offset:0 lds
  buffer_load_dwordx4 v10, s[36:39], s61 offen offset:1024 lds
  buffer_load_dwordx4 v10, s[36:39], s61 offen offset:2048 lds
  buffer_load_dwordx4 v10, s[36:39], s61 offen offset:3072 lds
  s_mov_b32 m0, 128000
  s_add_u32 s61, s86, 36864
  buffer_load_dwordx4 v10, s[36:39], s61 offen offset:0 lds
  buffer_load_dwordx4 v10, s[36:39], s61 offen offset:1024 lds
  buffer_load_dwordx4 v10, s[36:39], s61 offen offset:2048 lds
  buffer_load_dwordx4 v10, s[36:39], s61 offen offset:3072 lds
  s_waitcnt vmcnt(16)
  s_barrier
  s_mov_b32 m0, 140288
  s_add_u32 s61, s85, 40960
  buffer_load_dwordx4 v10, s[36:39], s61 offen offset:0 lds
  buffer_load_dwordx4 v10, s[36:39], s61 offen offset:1024 lds
  buffer_load_dwordx4 v10, s[36:39], s61 offen offset:2048 lds
  buffer_load_dwordx4 v10, s[36:39], s61 offen offset:3072 lds
  s_mov_b32 m0, 144384
  s_add_u32 s61, s85, 45056
  buffer_load_dwordx4 v10, s[36:39], s61 offen offset:0 lds
  buffer_load_dwordx4 v10, s[36:39], s61 offen offset:1024 lds
  buffer_load_dwordx4 v10, s[36:39], s61 offen offset:2048 lds
  buffer_load_dwordx4 v10, s[36:39], s61 offen offset:3072 lds
  s_waitcnt vmcnt(16)
  s_barrier
  s_mov_b32 m0, 82944
  s_add_u32 s61, s84, 49152
  buffer_load_dwordx4 v10, s[36:39], s61 offen offset:0 lds
  buffer_load_dwordx4 v10, s[36:39], s61 offen offset:1024 lds
  buffer_load_dwordx4 v10, s[36:39], s61 offen offset:2048 lds
  buffer_load_dwordx4 v10, s[36:39], s61 offen offset:3072 lds
  s_mov_b32 m0, 87040
  s_add_u32 s61, s84, 53248
  buffer_load_dwordx4 v10, s[36:39], s61 offen offset:0 lds
  buffer_load_dwordx4 v10, s[36:39], s61 offen offset:1024 lds
  buffer_load_dwordx4 v10, s[36:39], s61 offen offset:2048 lds
  buffer_load_dwordx4 v10, s[36:39], s61 offen offset:3072 lds
  s_waitcnt vmcnt(16)
  s_barrier
  s_mov_b32 m0, 99328
  s_add_u32 s61, s86, 49152
  buffer_load_dwordx4 v10, s[36:39], s61 offen offset:0 lds
  buffer_load_dwordx4 v10, s[36:39], s61 offen offset:1024 lds
  buffer_load_dwordx4 v10, s[36:39], s61 offen offset:2048 lds
  buffer_load_dwordx4 v10, s[36:39], s61 offen offset:3072 lds
  s_mov_b32 m0, 103424
  s_add_u32 s61, s86, 53248
  buffer_load_dwordx4 v10, s[36:39], s61 offen offset:0 lds
  buffer_load_dwordx4 v10, s[36:39], s61 offen offset:1024 lds
  buffer_load_dwordx4 v10, s[36:39], s61 offen offset:2048 lds
  buffer_load_dwordx4 v10, s[36:39], s61 offen offset:3072 lds
  s_waitcnt vmcnt(16)
  s_barrier
  s_mov_b32 m0, 115712
  s_add_u32 s61, s85, 57344
  buffer_load_dwordx4 v10, s[36:39], s61 offen offset:0 lds
  buffer_load_dwordx4 v10, s[36:39], s61 offen offset:1024 lds
  buffer_load_dwordx4 v10, s[36:39], s61 offen offset:2048 lds
  buffer_load_dwordx4 v10, s[36:39], s61 offen offset:3072 lds
  s_mov_b32 m0, 119808
  s_add_u32 s61, s85, 61440
  buffer_load_dwordx4 v10, s[36:39], s61 offen offset:0 lds
  buffer_load_dwordx4 v10, s[36:39], s61 offen offset:1024 lds
  buffer_load_dwordx4 v10, s[36:39], s61 offen offset:2048 lds
  buffer_load_dwordx4 v10, s[36:39], s61 offen offset:3072 lds
  s_waitcnt vmcnt(16)
  s_barrier
  s_mov_b32 m0, 132096
  s_add_u32 s61, s84, 65536
  buffer_load_dwordx4 v10, s[36:39], s61 offen offset:0 lds
  buffer_load_dwordx4 v10, s[36:39], s61 offen offset:1024 lds
  buffer_load_dwordx4 v10, s[36:39], s61 offen offset:2048 lds
  buffer_load_dwordx4 v10, s[36:39], s61 offen offset:3072 lds
  s_mov_b32 m0, 136192
  s_add_u32 s61, s84, 69632
  buffer_load_dwordx4 v10, s[36:39], s61 offen offset:0 lds
  buffer_load_dwordx4 v10, s[36:39], s61 offen offset:1024 lds
  buffer_load_dwordx4 v10, s[36:39], s61 offen offset:2048 lds
  buffer_load_dwordx4 v10, s[36:39], s61 offen offset:3072 lds
  s_waitcnt vmcnt(16)
  s_barrier
  s_mov_b32 m0, 148480
  s_add_u32 s61, s86, 65536
  buffer_load_dwordx4 v10, s[36:39], s61 offen offset:0 lds
  buffer_load_dwordx4 v10, s[36:39], s61 offen offset:1024 lds
  buffer_load_dwordx4 v10, s[36:39], s61 offen offset:2048 lds
  buffer_load_dwordx4 v10, s[36:39], s61 offen offset:3072 lds
  s_mov_b32 m0, 152576
  s_add_u32 s61, s86, 69632
  buffer_load_dwordx4 v10, s[36:39], s61 offen offset:0 lds
  buffer_load_dwordx4 v10, s[36:39], s61 offen offset:1024 lds
  buffer_load_dwordx4 v10, s[36:39], s61 offen offset:2048 lds
  buffer_load_dwordx4 v10, s[36:39], s61 offen offset:3072 lds
  s_waitcnt vmcnt(16)
  s_barrier
  s_waitcnt vmcnt(8)
  s_barrier
  s_waitcnt vmcnt(0)
  s_barrier
  s_barrier
  s_barrier
  s_branch L_tail
L_compute:
  s_lshr_b32 s50, s43, 1
  s_and_b32 s51, s43, 1
  v_lshrrev_b32 v11, 4, v0
  v_bfe_u32 v12, v0, 2, 2
  v_and_b32 v13, 3, v0
  v_and_b32 v14, 1, v11
  v_and_b32 v15, 15, v0
  v_lshl_add_u32 v16, v11, 3, v12
  v_mul_u32_u24 v16, 576, v16
  v_lshl_add_u32 v16, v13, 3, v16
  v_lshlrev_b32 v17, 5, v14
  s_mul_i32 s52, s51, 320
  s_add_u32 s52, s52, 16384
  v_add_u32 v18, s52, v16
  v_add_u32 v2, v18, v17
  v_sub_u32 v3, v18, v17
  s_lshl_b32 s52, s51, 5
  s_add_u32 s52, s52, 16640
  s_lshl_b32 s53, s51, 1
  s_sub_u32 s53, 1, s53
  v_mul_lo_u32 v18, v17, s53
  v_add3_u32 v4, v16, v18, s52
  v_lshrrev_b32 v17, 1, v15
  v_xor_b32 v18, v11, v17
  v_xor_b32 v19, 4, v18
  s_lshl_b32 s52, s50, 13
  s_add_u32 s52, s52, 0
  v_lshlrev_b32 v20, 7, v15
  v_add_u32 v20, s52, v20
  v_lshl_add_u32 v5, v18, 4, v20
  v_lshl_add_u32 v6, v19, 4, v20
  v_lshl_add_u32 v16, v11, 2, v12
  v_mul_u32_u24 v16, 288, v16
  v_lshl_add_u32 v16, v13, 3, v16
  s_mul_i32 s52, s51, 9216
  s_add_u32 s52, s52, 0
  v_add_u32 v9, s52, v16
  s_lshl_b32 s52, s50, 12
  s_mul_i32 s53, s51, 8192
  s_add_u32 s52, s52, s53
  s_add_u32 s52, s52, 82944
  s_lshl_b32 s53, s51, 11
  s_add_u32 s54, s52, s53
  v_add_u32 v7, s54, v10
  s_sub_u32 s54, s52, s53
  s_add_u32 s54, s54, 2048
  v_add_u32 v8, s54, v10
  s_cmp_lg_u32 s43, 0
  s_cbranch_scc1 L_noinit
  v_lshlrev_b32 v16, 2, v0
  v_mov_b32 v17, 0
  v_mov_b32 v18, 1
  s_mov_b64 exec, 0xffff
  buffer_store_dword v17, v16, s[36:39], s96 offen sc1
  s_waitcnt vmcnt(0)
  s_mov_b64 exec, 1
  s_lshl_b32 s52, s40, 4
  buffer_atomic_add v18, v17, s[32:35], s52 offen sc1
  s_mov_b64 exec, -1
L_noinit:
  v_mov_b32 v112, 0
  v_mov_b32 v113, 0
  v_mov_b32 v114, 0
  v_mov_b32 v115, 0
  v_mov_b32 v116, 0
  v_mov_b32 v117, 0
  v_mov_b32 v118, 0
  v_mov_b32 v119, 0
  v_mov_b32 v120, 0
  v_mov_b32 v121, 0
  v_mov_b32 v122, 0
  v_mov_b32 v123, 0
  v_mov_b32 v124, 0
  v_mov_b32 v125, 0
  v_mov_b32 v126, 0
  v_mov_b32 v127, 0
  v_mov_b32 v128, 0
  v_mov_b32 v129, 0
  v_mov_b32 v130, 0
  v_mov_b32 v131, 0
  v_mov_b32 v132, 0
  v_mov_b32 v133, 0
  v_mov_b32 v134, 0
  v_mov_b32 v135, 0
  v_mov_b32 v136, 0
  v_mov_b32 v137, 0
  v_mov_b32 v138, 0
  v_mov_b32 v139, 0
  v_mov_b32 v140, 0
  v_mov_b32 v141, 0
  v_mov_b32 v142, 0
  v_mov_b32 v143, 0
  v_mov_b32 v144, 0
  v_mov_b32 v145, 0
  v_mov_b32 v146, 0
  v_mov_b32 v147, 0
  v_mov_b32 v148, 0
  v_mov_b32 v149, 0
  v_mov_b32 v150, 0
  v_mov_b32 v151, 0
  v_mov_b32 v152, 0
  v_mov_b32 v153, 0
  v_mov_b32 v154, 0
  v_mov_b32 v155, 0
  v_mov_b32 v156, 0
  v_mov_b32 v157, 0
  v_mov_b32 v158, 0
  v_mov_b32 v159, 0
  v_mov_b32 v160, 0
  v_mov_b32 v161, 0
  v_mov_b32 v162, 0
  v_mov_b32 v163, 0
  v_mov_b32 v164, 0
  v_mov_b32 v165, 0
  v_mov_b32 v166, 0
  v_mov_b32 v167, 0
  v_mov_b32 v168, 0
  v_mov_b32 v169, 0
  v_mov_b32 v170, 0
  v_mov_b32 v171, 0
  v_mov_b32 v172, 0
  v_mov_b32 v173, 0
  v_mov_b32 v174, 0
  v_mov_b32 v175, 0
  v_mov_b32 v176, 0
  v_mov_b32 v177, 0
  v_mov_b32 v178, 0
  v_mov_b32 v179, 0
  v_mov_b32 v180, 0
  v_mov_b32 v181, 0
  v_mov_b32 v182, 0
  v_mov_b32 v183, 0
  v_mov_b32 v184, 0
  v_mov_b32 v185, 0
  v_mov_b32 v186, 0
  v_mov_b32 v187, 0
  v_mov_b32 v188, 0
  v_mov_b32 v189, 0
  v_mov_b32 v190, 0
  v_mov_b32 v191, 0
  v_mov_b32 v192, 0
  v_mov_b32 v193, 0
  v_mov_b32 v194, 0
  v_mov_b32 v195, 0
  v_mov_b32 v196, 0
  v_mov_b32 v197, 0
  v_mov_b32 v198, 0
  v_mov_b32 v199, 0
  v_mov_b32 v200, 0
  v_mov_b32 v201, 0
  v_mov_b32 v202, 0
  v_mov_b32 v203, 0
  v_mov_b32 v204, 0
  v_mov_b32 v205, 0
  v_mov_b32 v206, 0
  v_mov_b32 v207, 0
  v_mov_b32 v208, 0
  v_mov_b32 v209, 0
  v_mov_b32 v210, 0
  v_mov_b32 v211, 0
  v_mov_b32 v212, 0
  v_mov_b32 v213, 0
  v_mov_b32 v214, 0
  v_mov_b32 v215, 0
  v_mov_b32 v216, 0
  v_mov_b32 v217, 0
  v_mov_b32 v218, 0
  v_mov_b32 v219, 0
  v_mov_b32 v220, 0
  v_mov_b32 v221, 0
  v_mov_b32 v222, 0
  v_mov_b32 v223, 0
  v_mov_b32 v224, 0
  v_mov_b32 v225, 0
  v_mov_b32 v226, 0
  v_mov_b32 v227, 0
  v_mov_b32 v228, 0
  v_mov_b32 v229, 0
  v_mov_b32 v230, 0
  v_mov_b32 v231, 0
  v_mov_b32 v232, 0
  v_mov_b32 v233, 0
  v_mov_b32 v234, 0
  v_mov_b32 v235, 0
  v_mov_b32 v236, 0
  v_mov_b32 v237, 0
  v_mov_b32 v238, 0
  v_mov_b32 v239, 0
  v_mov_b32 v240, 0
  v_mov_b32 v241, 0
  v_mov_b32 v242, 0
  v_mov_b32 v243, 0
  v_mov_b32 v244, 0
  v_mov_b32 v245, 0
  v_mov_b32 v246, 0
  v_mov_b32 v247, 0
  v_mov_b32 v248, 0
  v_mov_b32 v249, 0
  v_mov_b32 v250, 0
  v_mov_b32 v251, 0
  v_mov_b32 v252, 0
  v_mov_b32 v253, 0
  v_mov_b32 v254, 0
  v_mov_b32 v255, 0
  s_mov_b32 s55, 0
  s_mov_b32 s57, 8
  s_mov_b32 s70, 53248
  s_mov_b32 s71, 4294860800
  s_mov_b32 s72, 16384
  s_mov_b32 s73, 4294909952
  s_mov_b32 s74, 18432
  s_mov_b32 s75, 4294902784
  s_barrier
  ds_read_b128 v[52:55], v5 offset:0
  ds_read_b128 v[56:59], v5 offset:2048
  ds_read_b128 v[60:63], v5 offset:4096
  ds_read_b128 v[64:67], v5 offset:6144
  ds_read_b64_tr_b16 v[16:17], v2 offset:0
  ds_read_b64_tr_b16 v[18:19], v2 offset:2304
  ds_read_b64_tr_b16 v[20:21], v3 offset:32
  ds_read_b64_tr_b16 v[22:23], v3 offset:2336
  ds_read_b64_tr_b16 v[24:25], v2 offset:64
  ds_read_b64_tr_b16 v[26:27], v2 offset:2368
  ds_read_b64_tr_b16 v[28:29], v3 offset:96
  ds_read_b64_tr_b16 v[30:31], v3 offset:2400
  ds_read_b64_tr_b16 v[32:33], v2 offset:128
  ds_read_b64_tr_b16 v[34:35], v2 offset:2432
  ds_read_b64_tr_b16 v[36:37], v3 offset:160
  ds_read_b64_tr_b16 v[38:39], v3 offset:2464
  ds_read_b64_tr_b16 v[40:41], v2 offset:192
  ds_read_b64_tr_b16 v[42:43], v2 offset:2496
  ds_read_b64_tr_b16 v[44:45], v3 offset:224
  ds_read_b64_tr_b16 v[46:47], v3 offset:2528
L_p1_loop:
  s_waitcnt lgkmcnt(14)
  v_mfma_f32_16x16x32_bf16 v[112:115], v[16:19], v[52:55], v[112:115]
  ds_read_b64_tr_b16 v[48:49], v4 offset:0
  v_mfma_f32_16x16x32_bf16 v[116:119], v[16:19], v[56:59], v[116:119]
  ds_read_b64_tr_b16 v[50:51], v4 offset:2304
  v_mfma_f32_16x16x32_bf16 v[120:123], v[16:19], v[60:63], v[120:123]
  v_mfma_f32_16x16x32_bf16 v[124:127], v[16:19], v[64:67], v[124:127]
  s_waitcnt lgkmcnt(14)
  v_mfma_f32_16x16x32_bf16 v[128:131], v[20:23], v[52:55], v[128:131]
  ds_read_b64_tr_b16 v[16:17], v2 offset:18432
  v_mfma_f32_16x16x32_bf16 v[132:135], v[20:23], v[56:59], v[132:135]
  ds_read_b64_tr_b16 v[18:19], v2 offset:20736
  v_mfma_f32_16x16x32_bf16 v[136:139], v[20:23], v[60:63], v[136:139]
  v_mfma_f32_16x16x32_bf16 v[140:143], v[20:23], v[64:67], v[140:143]
  s_waitcnt lgkmcnt(14)
  v_mfma_f32_16x16x32_bf16 v[144:147], v[24:27], v[52:55], v[144:147]
  ds_read_b64_tr_b16 v[20:21], v3 offset:18464
  v_mfma_f32_16x16x32_bf16 v[148:151], v[24:27], v[56:59], v[148:151]
  ds_read_b64_tr_b16 v[22:23], v3 offset:20768
  v_mfma_f32_16x16x32_bf16 v[152:155], v[24:27], v[60:63], v[152:155]
  v_mfma_f32_16x16x32_bf16 v[156:159], v[24:27], v[64:67], v[156:159]
  s_waitcnt lgkmcnt(14)
  v_mfma_f32_16x16x32_bf16 v[160:163], v[28:31], v[52:55], v[160:163]
  ds_read_b64_tr_b16 v[24:25], v2 offset:18496
  v_mfma_f32_16x16x32_bf16 v[164:167], v[28:31], v[56:59], v[164:167]
  ds_read_b64_tr_b16 v[26:27], v2 offset:20800
  v_mfma_f32_16x16x32_bf16 v[168:171], v[28:31], v[60:63], v[168:171]
  v_mfma_f32_16x16x32_bf16 v[172:175], v[28:31], v[64:67], v[172:175]
  s_waitcnt lgkmcnt(14)
  v_mfma_f32_16x16x32_bf16 v[176:179], v[32:35], v[52:55], v[176:179]
  ds_read_b64_tr_b16 v[28:29], v3 offset:18528
  v_mfma_f32_16x16x32_bf16 v[180:183], v[32:35], v[56:59], v[180:183]
  ds_read_b64_tr_b16 v[30:31], v3 offset:20832
  v_mfma_f32_16x16x32_bf16 v[184:187], v[32:35], v[60:63], v[184:187]
  ds_read_b128 v[68:71], v6 offset:0
  v_mfma_f32_16x16x32_bf16 v[188:191], v[32:35], v[64:67], v[188:191]
  ds_read_b128 v[72:75], v6 offset:2048
  s_waitcnt lgkmcnt(15)
  v_mfma_f32_16x16x32_bf16 v[192:195], v[36:39], v[52:55], v[192:195]
  ds_read_b128 v[76:79], v6 offset:4096
  v_mfma_f32_16x16x32_bf16 v[196:199], v[36:39], v[56:59], v[196:199]
  ds_read_b128 v[80:83], v6 offset:6144
  v_mfma_f32_16x16x32_bf16 v[200:203], v[36:39], v[60:63], v[200:203]
  ds_read_b64_tr_b16 v[32:33], v2 offset:18560
  v_mfma_f32_16x16x32_bf16 v[204:207], v[36:39], v[64:67], v[204:207]
  ds_read_b64_tr_b16 v[34:35], v2 offset:20864
  s_waitcnt lgkmcnt(15)
  v_mfma_f32_16x16x32_bf16 v[208:211], v[40:43], v[52:55], v[208:211]
  ds_read_b64_tr_b16 v[36:37], v3 offset:18592
  v_mfma_f32_16x16x32_bf16 v[212:215], v[40:43], v[56:59], v[212:215]
  ds_read_b64_tr_b16 v[38:39], v3 offset:20896
  v_mfma_f32_16x16x32_bf16 v[216:219], v[40:43], v[60:63], v[216:219]
  v_mfma_f32_16x16x32_bf16 v[220:223], v[40:43], v[64:67], v[220:223]
  s_waitcnt lgkmcnt(15)
  v_mfma_f32_16x16x32_bf16 v[224:227], v[44:47], v[52:55], v[224:227]
  ds_read_b64_tr_b16 v[40:41], v2 offset:18624
  v_mfma_f32_16x16x32_bf16 v[228:231], v[44:47], v[56:59], v[228:231]
  ds_read_b64_tr_b16 v[42:43], v2 offset:20928
  v_mfma_f32_16x16x32_bf16 v[232:235], v[44:47], v[60:63], v[232:235]
  v_mfma_f32_16x16x32_bf16 v[236:239], v[44:47], v[64:67], v[236:239]
  s_waitcnt lgkmcnt(15)
  v_mfma_f32_16x16x32_bf16 v[240:243], v[48:51], v[52:55], v[240:243]
  ds_read_b64_tr_b16 v[44:45], v3 offset:18656
  v_mfma_f32_16x16x32_bf16 v[244:247], v[48:51], v[56:59], v[244:247]
  ds_read_b64_tr_b16 v[46:47], v3 offset:20960
  v_mfma_f32_16x16x32_bf16 v[248:251], v[48:51], v[60:63], v[248:251]
  v_mfma_f32_16x16x32_bf16 v[252:255], v[48:51], v[64:67], v[252:255]
  s_waitcnt lgkmcnt(8)
  v_mfma_f32_16x16x32_bf16 v[112:115], v[16:19], v[68:71], v[112:115]
  ds_read_b64_tr_b16 v[48:49], v4 offset:18432
  v_mfma_f32_16x16x32_bf16 v[116:119], v[16:19], v[72:75], v[116:119]
  ds_read_b64_tr_b16 v[50:51], v4 offset:20736
  v_mfma_f32_16x16x32_bf16 v[120:123], v[16:19], v[76:79], v[120:123]
  s_add_u32 s55, s55, 1
  s_cmp_eq_u32 s55, 3
  s_cselect_b32 s56, s71, s70
  s_cselect_b32 s55, 0, s55
  v_mfma_f32_16x16x32_bf16 v[124:127], v[16:19], v[80:83], v[124:127]
  v_add_u32 v2, s56, v2
  s_waitcnt lgkmcnt(15)
  v_mfma_f32_16x16x32_bf16 v[128:131], v[20:23], v[68:71], v[128:131]
  v_add_u32 v3, s56, v3
  v_mfma_f32_16x16x32_bf16 v[132:135], v[20:23], v[72:75], v[132:135]
  v_add_u32 v4, s56, v4
  v_mfma_f32_16x16x32_bf16 v[136:139], v[20:23], v[76:79], v[136:139]
  v_add_u32 v5, s56, v5
  v_mfma_f32_16x16x32_bf16 v[140:143], v[20:23], v[80:83], v[140:143]
  v_add_u32 v6, s56, v6
  s_waitcnt lgkmcnt(15)
  v_mfma_f32_16x16x32_bf16 v[144:147], v[24:27], v[68:71], v[144:147]
  v_mfma_f32_16x16x32_bf16 v[148:151], v[24:27], v[72:75], v[148:151]
  v_mfma_f32_16x16x32_bf16 v[152:155], v[24:27], v[76:79], v[152:155]
  v_mfma_f32_16x16x32_bf16 v[156:159], v[24:27], v[80:83], v[156:159]
  s_waitcnt lgkmcnt(0)
  s_barrier
  s_waitcnt lgkmcnt(15)
  v_mfma_f32_16x16x32_bf16 v[160:163], v[28:31], v[68:71], v[160:163]
  ds_read_b128 v[52:55], v5 offset:0
  v_mfma_f32_16x16x32_bf16 v[164:167], v[28:31], v[72:75], v[164:167]
  ds_read_b128 v[56:59], v5 offset:2048
  v_mfma_f32_16x16x32_bf16 v[168:171], v[28:31], v[76:79], v[168:171]
  ds_read_b128 v[60:63], v5 offset:4096
  v_mfma_f32_16x16x32_bf16 v[172:175], v[28:31], v[80:83], v[172:175]
  ds_read_b128 v[64:67], v5 offset:6144
  s_waitcnt lgkmcnt(15)
  v_mfma_f32_16x16x32_bf16 v[176:179], v[32:35], v[68:71], v[176:179]
  ds_read_b64_tr_b16 v[16:17], v2 offset:0
  v_mfma_f32_16x16x32_bf16 v[180:183], v[32:35], v[72:75], v[180:183]
  ds_read_b64_tr_b16 v[18:19], v2 offset:2304
  v_mfma_f32_16x16x32_bf16 v[184:187], v[32:35], v[76:79], v[184:187]
  ds_read_b64_tr_b16 v[20:21], v3 offset:32
  v_mfma_f32_16x16x32_bf16 v[188:191], v[32:35], v[80:83], v[188:191]
  ds_read_b64_tr_b16 v[22:23], v3 offset:2336
  s_waitcnt lgkmcnt(15)
  v_mfma_f32_16x16x32_bf16 v[192:195], v[36:39], v[68:71], v[192:195]
  ds_read_b64_tr_b16 v[24:25], v2 offset:64
  v_mfma_f32_16x16x32_bf16 v[196:199], v[36:39], v[72:75], v[196:199]
  ds_read_b64_tr_b16 v[26:27], v2 offset:2368
  v_mfma_f32_16x16x32_bf16 v[200:203], v[36:39], v[76:79], v[200:203]
  ds_read_b64_tr_b16 v[28:29], v3 offset:96
  v_mfma_f32_16x16x32_bf16 v[204:207], v[36:39], v[80:83], v[204:207]
  ds_read_b64_tr_b16 v[30:31], v3 offset:2400
  s_waitcnt lgkmcnt(15)
  v_mfma_f32_16x16x32_bf16 v[208:211], v[40:43], v[68:71], v[208:211]
  ds_read_b64_tr_b16 v[32:33], v2 offset:128
  v_mfma_f32_16x16x32_bf16 v[212:215], v[40:43], v[72:75], v[212:215]
  ds_read_b64_tr_b16 v[34:35], v2 offset:2432
  v_mfma_f32_16x16x32_bf16 v[216:219], v[40:43], v[76:79], v[216:219]
  ds_read_b64_tr_b16 v[36:37], v3 offset:160
  v_mfma_f32_16x16x32_bf16 v[220:223], v[40:43], v[80:83], v[220:223]
  ds_read_b64_tr_b16 v[38:39], v3 offset:2464
  s_waitcnt lgkmcnt(15)
  v_mfma_f32_16x16x32_bf16 v[224:227], v[44:47], v[68:71], v[224:227]
  ds_read_b64_tr_b16 v[40:41], v2 offset:192
  v_mfma_f32_16x16x32_bf16 v[228:231], v[44:47], v[72:75], v[228:231]
  ds_read_b64_tr_b16 v[42:43], v2 offset:2496
  v_mfma_f32_16x16x32_bf16 v[232:235], v[44:47], v[76:79], v[232:235]
  v_mfma_f32_16x16x32_bf16 v[236:239], v[44:47], v[80:83], v[236:239]
  s_waitcnt lgkmcnt(15)
  v_mfma_f32_16x16x32_bf16 v[240:243], v[48:51], v[68:71], v[240:243]
  ds_read_b64_tr_b16 v[44:45], v3 offset:224
  v_mfma_f32_16x16x32_bf16 v[244:247], v[48:51], v[72:75], v[244:247]
  ds_read_b64_tr_b16 v[46:47], v3 offset:2528
  v_mfma_f32_16x16x32_bf16 v[248:251], v[48:51], v[76:79], v[248:251]
  v_mfma_f32_16x16x32_bf16 v[252:255], v[48:51], v[80:83], v[252:255]
  s_sub_u32 s57, s57, 1
  s_cmp_lg_u32 s57, 0
  s_cbranch_scc1 L_p1_loop
  s_waitcnt lgkmcnt(14)
  v_mfma_f32_16x16x32_bf16 v[112:115], v[16:19], v[52:55], v[112:115]
  ds_read_b64_tr_b16 v[48:49], v4 offset:0
  v_mfma_f32_16x16x32_bf16 v[116:119], v[16:19], v[56:59], v[116:119]
  ds_read_b64_tr_b16 v[50:51], v4 offset:2304
  v_mfma_f32_16x16x32_bf16 v[120:123], v[16:19], v[60:63], v[120:123]
  v_mfma_f32_16x16x32_bf16 v[124:127], v[16:19], v[64:67], v[124:127]
  s_waitcnt lgkmcnt(14)
  v_mfma_f32_16x16x32_bf16 v[128:131], v[20:23], v[52:55], v[128:131]
  ds_read_b64_tr_b16 v[16:17], v2 offset:18432
  v_mfma_f32_16x16x32_bf16 v[132:135], v[20:23], v[56:59], v[132:135]
  ds_read_b64_tr_b16 v[18:19], v2 offset:20736
  v_mfma_f32_16x16x32_bf16 v[136:139], v[20:23], v[60:63], v[136:139]
  v_mfma_f32_16x16x32_bf16 v[140:143], v[20:23], v[64:67], v[140:143]
  s_waitcnt lgkmcnt(14)
  v_mfma_f32_16x16x32_bf16 v[144:147], v[24:27], v[52:55], v[144:147]
  ds_read_b64_tr_b16 v[20:21], v3 offset:18464
  v_mfma_f32_16x16x32_bf16 v[148:151], v[24:27], v[56:59], v[148:151]
  ds_read_b64_tr_b16 v[22:23], v3 offset:20768
  v_mfma_f32_16x16x32_bf16 v[152:155], v[24:27], v[60:63], v[152:155]
  v_mfma_f32_16x16x32_bf16 v[156:159], v[24:27], v[64:67], v[156:159]
  s_waitcnt lgkmcnt(14)
  v_mfma_f32_16x16x32_bf16 v[160:163], v[28:31], v[52:55], v[160:163]
  ds_read_b64_tr_b16 v[24:25], v2 offset:18496
  v_mfma_f32_16x16x32_bf16 v[164:167], v[28:31], v[56:59], v[164:167]
  ds_read_b64_tr_b16 v[26:27], v2 offset:20800
  v_mfma_f32_16x16x32_bf16 v[168:171], v[28:31], v[60:63], v[168:171]
  v_mfma_f32_16x16x32_bf16 v[172:175], v[28:31], v[64:67], v[172:175]
  s_waitcnt lgkmcnt(14)
  v_mfma_f32_16x16x32_bf16 v[176:179], v[32:35], v[52:55], v[176:179]
  ds_read_b64_tr_b16 v[28:29], v3 offset:18528
  v_mfma_f32_16x16x32_bf16 v[180:183], v[32:35], v[56:59], v[180:183]
  ds_read_b64_tr_b16 v[30:31], v3 offset:20832
  v_mfma_f32_16x16x32_bf16 v[184:187], v[32:35], v[60:63], v[184:187]
  ds_read_b128 v[68:71], v6 offset:0
  v_mfma_f32_16x16x32_bf16 v[188:191], v[32:35], v[64:67], v[188:191]
  ds_read_b128 v[72:75], v6 offset:2048
  s_waitcnt lgkmcnt(15)
  v_mfma_f32_16x16x32_bf16 v[192:195], v[36:39], v[52:55], v[192:195]
  ds_read_b128 v[76:79], v6 offset:4096
  v_mfma_f32_16x16x32_bf16 v[196:199], v[36:39], v[56:59], v[196:199]
  ds_read_b128 v[80:83], v6 offset:6144
  v_mfma_f32_16x16x32_bf16 v[200:203], v[36:39], v[60:63], v[200:203]
  ds_read_b64_tr_b16 v[32:33], v2 offset:18560
  v_mfma_f32_16x16x32_bf16 v[204:207], v[36:39], v[64:67], v[204:207]
  ds_read_b64_tr_b16 v[34:35], v2 offset:20864
  s_waitcnt lgkmcnt(15)
  v_mfma_f32_16x16x32_bf16 v[208:211], v[40:43], v[52:55], v[208:211]
  ds_read_b64_tr_b16 v[36:37], v3 offset:18592
  v_mfma_f32_16x16x32_bf16 v[212:215], v[40:43], v[56:59], v[212:215]
  ds_read_b64_tr_b16 v[38:39], v3 offset:20896
  v_mfma_f32_16x16x32_bf16 v[216:219], v[40:43], v[60:63], v[216:219]
  v_mfma_f32_16x16x32_bf16 v[220:223], v[40:43], v[64:67], v[220:223]
  s_waitcnt lgkmcnt(15)
  v_mfma_f32_16x16x32_bf16 v[224:227], v[44:47], v[52:55], v[224:227]
  ds_read_b64_tr_b16 v[40:41], v2 offset:18624
  v_mfma_f32_16x16x32_bf16 v[228:231], v[44:47], v[56:59], v[228:231]
  ds_read_b64_tr_b16 v[42:43], v2 offset:20928
  v_mfma_f32_16x16x32_bf16 v[232:235], v[44:47], v[60:63], v[232:235]
  v_mfma_f32_16x16x32_bf16 v[236:239], v[44:47], v[64:67], v[236:239]
  s_waitcnt lgkmcnt(15)
  v_mfma_f32_16x16x32_bf16 v[240:243], v[48:51], v[52:55], v[240:243]
  ds_read_b64_tr_b16 v[44:45], v3 offset:18656
  v_mfma_f32_16x16x32_bf16 v[244:247], v[48:51], v[56:59], v[244:247]
  ds_read_b64_tr_b16 v[46:47], v3 offset:20960
  v_mfma_f32_16x16x32_bf16 v[248:251], v[48:51], v[60:63], v[248:251]
  v_mfma_f32_16x16x32_bf16 v[252:255], v[48:51], v[64:67], v[252:255]
  s_waitcnt lgkmcnt(8)
  v_mfma_f32_16x16x32_bf16 v[112:115], v[16:19], v[68:71], v[112:115]
  ds_read_b64_tr_b16 v[48:49], v4 offset:18432
  v_mfma_f32_16x16x32_bf16 v[116:119], v[16:19], v[72:75], v[116:119]
  ds_read_b64_tr_b16 v[50:51], v4 offset:20736
  v_mfma_f32_16x16x32_bf16 v[120:123], v[16:19], v[76:79], v[120:123]
  v_mfma_f32_16x16x32_bf16 v[124:127], v[16:19], v[80:83], v[124:127]
  s_waitcnt lgkmcnt(15)
  v_mfma_f32_16x16x32_bf16 v[128:131], v[20:23], v[68:71], v[128:131]
  v_mfma_f32_16x16x32_bf16 v[132:135], v[20:23], v[72:75], v[132:135]
  v_mfma_f32_16x16x32_bf16 v[136:139], v[20:23], v[76:79], v[136:139]
  v_mfma_f32_16x16x32_bf16 v[140:143], v[20:23], v[80:83], v[140:143]
  s_waitcnt lgkmcnt(15)
  v_mfma_f32_16x16x32_bf16 v[144:147], v[24:27], v[68:71], v[144:147]
  v_mfma_f32_16x16x32_bf16 v[148:151], v[24:27], v[72:75], v[148:151]
  v_mfma_f32_16x16x32_bf16 v[152:155], v[24:27], v[76:79], v[152:155]
  v_mfma_f32_16x16x32_bf16 v[156:159], v[24:27], v[80:83], v[156:159]
  s_waitcnt lgkmcnt(0)
  s_barrier
  s_waitcnt lgkmcnt(15)
  v_mfma_f32_16x16x32_bf16 v[160:163], v[28:31], v[68:71], v[160:163]
  v_mfma_f32_16x16x32_bf16 v[164:167], v[28:31], v[72:75], v[164:167]
  v_mfma_f32_16x16x32_bf16 v[168:171], v[28:31], v[76:79], v[168:171]
  v_mfma_f32_16x16x32_bf16 v[172:175], v[28:31], v[80:83], v[172:175]
  s_waitcnt lgkmcnt(15)
  v_mfma_f32_16x16x32_bf16 v[176:179], v[32:35], v[68:71], v[176:179]
  v_mfma_f32_16x16x32_bf16 v[180:183], v[32:35], v[72:75], v[180:183]
  v_mfma_f32_16x16x32_bf16 v[184:187], v[32:35], v[76:79], v[184:187]
  v_mfma_f32_16x16x32_bf16 v[188:191], v[32:35], v[80:83], v[188:191]
  s_waitcnt lgkmcnt(15)
  v_mfma_f32_16x16x32_bf16 v[192:195], v[36:39], v[68:71], v[192:195]
  v_mfma_f32_16x16x32_bf16 v[196:199], v[36:39], v[72:75], v[196:199]
  v_mfma_f32_16x16x32_bf16 v[200:203], v[36:39], v[76:79], v[200:203]
  v_mfma_f32_16x16x32_bf16 v[204:207], v[36:39], v[80:83], v[204:207]
  s_waitcnt lgkmcnt(15)
  v_mfma_f32_16x16x32_bf16 v[208:211], v[40:43], v[68:71], v[208:211]
  v_mfma_f32_16x16x32_bf16 v[212:215], v[40:43], v[72:75], v[212:215]
  v_mfma_f32_16x16x32_bf16 v[216:219], v[40:43], v[76:79], v[216:219]
  v_mfma_f32_16x16x32_bf16 v[220:223], v[40:43], v[80:83], v[220:223]
  s_waitcnt lgkmcnt(15)
  v_mfma_f32_16x16x32_bf16 v[224:227], v[44:47], v[68:71], v[224:227]
  v_mfma_f32_16x16x32_bf16 v[228:231], v[44:47], v[72:75], v[228:231]
  v_mfma_f32_16x16x32_bf16 v[232:235], v[44:47], v[76:79], v[232:235]
  v_mfma_f32_16x16x32_bf16 v[236:239], v[44:47], v[80:83], v[236:239]
  s_waitcnt lgkmcnt(15)
  v_mfma_f32_16x16x32_bf16 v[240:243], v[48:51], v[68:71], v[240:243]
  v_mfma_f32_16x16x32_bf16 v[244:247], v[48:51], v[72:75], v[244:247]
  v_mfma_f32_16x16x32_bf16 v[248:251], v[48:51], v[76:79], v[248:251]
  v_mfma_f32_16x16x32_bf16 v[252:255], v[48:51], v[80:83], v[252:255]
  s_mul_i32 s52, s51, 5
  s_add_u32 s52, s52, 9
  s_sub_u32 s52, s52, s45
  s_cmp_ge_u32 s52, 9
  s_cselect_b32 s53, 9, 0
  s_sub_u32 s52, s52, s53
  s_lshl_b32 s52, s52, 13
  s_lshl_b32 s53, s50, 12
  s_add_u32 s60, s52, s53
  s_mul_i32 s52, s51, 5
  s_add_u32 s52, s52, 10
  s_sub_u32 s52, s52, s45
  s_cmp_ge_u32 s52, 9
  s_cselect_b32 s53, 9, 0
  s_sub_u32 s52, s52, s53
  s_lshl_b32 s52, s52, 13
  s_lshl_b32 s53, s50, 12
  s_add_u32 s61, s52, s53
  s_mul_i32 s52, s51, 5
  s_add_u32 s52, s52, 11
  s_sub_u32 s52, s52, s45
  s_cmp_ge_u32 s52, 9
  s_cselect_b32 s53, 9, 0
  s_sub_u32 s52, s52, s53
  s_lshl_b32 s52, s52, 13
  s_lshl_b32 s53, s50, 12
  s_add_u32 s62, s52, s53
  s_mul_i32 s52, s51, 5
  s_add_u32 s52, s52, 12
  s_sub_u32 s52, s52, s45
  s_cmp_ge_u32 s52, 9
  s_cselect_b32 s53, 9, 0
  s_sub_u32 s52, s52, s53
  s_lshl_b32 s52, s52, 13
  s_lshl_b32 s53, s50, 12
  s_add_u32 s63, s52, s53
  s_mov_b32 s52, 13
  s_sub_u32 s52, s52, s45
  s_cmp_ge_u32 s52, 9
  s_cselect_b32 s53, 9, 0
  s_sub_u32 s52, s52, s53
  s_lshl_b32 s52, s52, 13
  s_lshl_b32 s53, s50, 12
  s_add_u32 s64, s52, s53
  s_lshl_b32 s52, s51, 3
  s_add_u32 s64, s64, s52
  s_lshl_b32 s52, s40, 4
  s_add_u32 s52, s52, s46
  s_mul_i32 s65, s52, 73728
  s_mov_b32 s66, 0xbfb8aa3b
  s_mov_b32 s67, 0xbfb8aa3b
  s_mov_b32 s68, 1.0
  s_mov_b32 s69, 1.0
  s_add_u32 s53, s60, 82944
  v_add_u32 v1, s53, v10
  s_add_u32 s52, s65, s60
  v_pk_mul_f32 v[16:17], v[112:113], s[66:67]
  v_pk_mul_f32 v[18:19], v[114:115], s[66:67]
  v_pk_mul_f32 v[20:21], v[128:129], s[66:67]
  v_pk_mul_f32 v[22:23], v[130:131], s[66:67]
  v_exp_f32 v16, v16
  v_exp_f32 v17, v17
  v_exp_f32 v18, v18
  v_exp_f32 v19, v19
  v_exp_f32 v20, v20
  v_exp_f32 v21, v21
  v_exp_f32 v22, v22
  v_exp_f32 v23, v23
  v_pk_add_f32 v[16:17], v[16:17], s[68:69]
  v_pk_add_f32 v[18:19], v[18:19], s[68:69]
  v_pk_add_f32 v[20:21], v[20:21], s[68:69]
  v_pk_add_f32 v[22:23], v[22:23], s[68:69]
  v_rcp_f32 v16, v16
  v_rcp_f32 v17, v17
  v_rcp_f32 v18, v18
  v_rcp_f32 v19, v19
  v_rcp_f32 v20, v20
  v_rcp_f32 v21, v21
  v_rcp_f32 v22, v22
  v_rcp_f32 v23, v23
  v_pk_mul_f32 v[16:17], v[112:113], v[16:17]
  v_pk_mul_f32 v[18:19], v[114:115], v[18:19]
  v_pk_mul_f32 v[20:21], v[128:129], v[20:21]
  v_pk_mul_f32 v[22:23], v[130:131], v[22:23]
  v_cvt_pk_bf16_f32 v48, v16, v17
  v_cvt_pk_bf16_f32 v49, v18, v19
  v_cvt_pk_bf16_f32 v50, v20, v21
  v_cvt_pk_bf16_f32 v51, v22, v23
  ds_write_b128 v1, v[48:51] offset:0
  buffer_store_dwordx4 v[48:51], v10, s[36:39], s52 offen offset:0 sc1
  v_pk_mul_f32 v[24:25], v[116:117], s[66:67]
  v_pk_mul_f32 v[26:27], v[118:119], s[66:67]
  v_pk_mul_f32 v[28:29], v[132:133], s[66:67]
  v_pk_mul_f32 v[30:31], v[134:135], s[66:67]
  v_exp_f32 v24, v24
  v_exp_f32 v25, v25
  v_exp_f32 v26, v26
  v_exp_f32 v27, v27
  v_exp_f32 v28, v28
  v_exp_f32 v29, v29
  v_exp_f32 v30, v30
  v_exp_f32 v31, v31
  v_pk_add_f32 v[24:25], v[24:25], s[68:69]
  v_pk_add_f32 v[26:27], v[26:27], s[68:69]
  v_pk_add_f32 v[28:29], v[28:29], s[68:69]
  v_pk_add_f32 v[30:31], v[30:31], s[68:69]
  v_rcp_f32 v24, v24
  v_rcp_f32 v25, v25
  v_rcp_f32 v26, v26
  v_rcp_f32 v27, v27
  v_rcp_f32 v28, v28
  v_rcp_f32 v29, v29
  v_rcp_f32 v30, v30
  v_rcp_f32 v31, v31
  v_pk_mul_f32 v[24:25], v[116:117], v[24:25]
  v_pk_mul_f32 v[26:27], v[118:119], v[26:27]
  v_pk_mul_f32 v[28:29], v[132:133], v[28:29]
  v_pk_mul_f32 v[30:31], v[134:135], v[30:31]
  v_cvt_pk_bf16_f32 v52, v24, v25
  v_cvt_pk_bf16_f32 v53, v26, v27
  v_cvt_pk_bf16_f32 v54, v28, v29
  v_cvt_pk_bf16_f32 v55, v30, v31
  ds_write_b128 v1, v[52:55] offset:1024
  buffer_store_dwordx4 v[52:55], v10, s[36:39], s52 offen offset:1024 sc1
  v_pk_mul_f32 v[32:33], v[120:121], s[66:67]
  v_pk_mul_f32 v[34:35], v[122:123], s[66:67]
  v_pk_mul_f32 v[36:37], v[136:137], s[66:67]
  v_pk_mul_f32 v[38:39], v[138:139], s[66:67]
  v_exp_f32 v32, v32
  v_exp_f32 v33, v33
  v_exp_f32 v34, v34
  v_exp_f32 v35, v35
  v_exp_f32 v36, v36
  v_exp_f32 v37, v37
  v_exp_f32 v38, v38
  v_exp_f32 v39, v39
  v_pk_add_f32 v[32:33], v[32:33], s[68:69]
  v_pk_add_f32 v[34:35], v[34:35], s[68:69]
  v_pk_add_f32 v[36:37], v[36:37], s[68:69]
  v_pk_add_f32 v[38:39], v[38:39], s[68:69]
  v_rcp_f32 v32, v32
  v_rcp_f32 v33, v33
  v_rcp_f32 v34, v34
  v_rcp_f32 v35, v35
  v_rcp_f32 v36, v36
  v_rcp_f32 v37, v37
  v_rcp_f32 v38, v38
  v_rcp_f32 v39, v39
  v_pk_mul_f32 v[32:33], v[120:121], v[32:33]
  v_pk_mul_f32 v[34:35], v[122:123], v[34:35]
  v_pk_mul_f32 v[36:37], v[136:137], v[36:37]
  v_pk_mul_f32 v[38:39], v[138:139], v[38:39]
  v_cvt_pk_bf16_f32 v56, v32, v33
  v_cvt_pk_bf16_f32 v57, v34, v35
  v_cvt_pk_bf16_f32 v58, v36, v37
  v_cvt_pk_bf16_f32 v59, v38, v39
  ds_write_b128 v1, v[56:59] offset:2048
  buffer_store_dwordx4 v[56:59], v10, s[36:39], s52 offen offset:2048 sc1
  v_pk_mul_f32 v[16:17], v[124:125], s[66:67]
  v_pk_mul_f32 v[18:19], v[126:127], s[66:67]
  v_pk_mul_f32 v[20:21], v[140:141], s[66:67]
  v_pk_mul_f32 v[22:23], v[142:143], s[66:67]
  v_exp_f32 v16, v16
  v_exp_f32 v17, v17
  v_exp_f32 v18, v18
  v_exp_f32 v19, v19
  v_exp_f32 v20, v20
  v_exp_f32 v21, v21
  v_exp_f32 v22, v22
  v_exp_f32 v23, v23
  v_pk_add_f32 v[16:17], v[16:17], s[68:69]
  v_pk_add_f32 v[18:19], v[18:19], s[68:69]
  v_pk_add_f32 v[20:21], v[20:21], s[68:69]
  v_pk_add_f32 v[22:23], v[22:23], s[68:69]
  v_rcp_f32 v16, v16
  v_rcp_f32 v17, v17
  v_rcp_f32 v18, v18
  v_rcp_f32 v19, v19
  v_rcp_f32 v20, v20
  v_rcp_f32 v21, v21
  v_rcp_f32 v22, v22
  v_rcp_f32 v23, v23
  v_pk_mul_f32 v[16:17], v[124:125], v[16:17]
  v_pk_mul_f32 v[18:19], v[126:127], v[18:19]
  v_pk_mul_f32 v[20:21], v[140:141], v[20:21]
  v_pk_mul_f32 v[22:23], v[142:143], v[22:23]
  v_cvt_pk_bf16_f32 v60, v16, v17
  v_cvt_pk_bf16_f32 v61, v18, v19
  v_cvt_pk_bf16_f32 v62, v20, v21
  v_cvt_pk_bf16_f32 v63, v22, v23
  ds_write_b128 v1, v[60:63] offset:3072
  buffer_store_dwordx4 v[60:63], v10, s[36:39], s52 offen offset:3072 sc1
  s_add_u32 s53, s61, 82944
  v_add_u32 v1, s53, v10
  s_add_u32 s52, s65, s61
  v_pk_mul_f32 v[24:25], v[144:145], s[66:67]
  v_pk_mul_f32 v[26:27], v[146:147], s[66:67]
  v_pk_mul_f32 v[28:29], v[160:161], s[66:67]
  v_pk_mul_f32 v[30:31], v[162:163], s[66:67]
  v_exp_f32 v24, v24
  v_exp_f32 v25, v25
  v_exp_f32 v26, v26
  v_exp_f32 v27, v27
  v_exp_f32 v28, v28
  v_exp_f32 v29, v29
  v_exp_f32 v30, v30
  v_exp_f32 v31, v31
  v_pk_add_f32 v[24:25], v[24:25], s[68:69]
  v_pk_add_f32 v[26:27], v[26:27], s[68:69]
  v_pk_add_f32 v[28:29], v[28:29], s[68:69]
  v_pk_add_f32 v[30:31], v[30:31], s[68:69]
  v_rcp_f32 v24, v24
  v_rcp_f32 v25, v25
  v_rcp_f32 v26, v26
  v_rcp_f32 v27, v27
  v_rcp_f32 v28, v28
  v_rcp_f32 v29, v29
  v_rcp_f32 v30, v30
  v_rcp_f32 v31, v31
  v_pk_mul_f32 v[24:25], v[144:145], v[24:25]
  v_pk_mul_f32 v[26:27], v[146:147], v[26:27]
  v_pk_mul_f32 v[28:29], v[160:161], v[28:29]
  v_pk_mul_f32 v[30:31], v[162:163], v[30:31]
  v_cvt_pk_bf16_f32 v48, v24, v25
  v_cvt_pk_bf16_f32 v49, v26, v27
  v_cvt_pk_bf16_f32 v50, v28, v29
  v_cvt_pk_bf16_f32 v51, v30, v31
  ds_write_b128 v1, v[48:51] offset:0
  buffer_store_dwordx4 v[48:51], v10, s[36:39], s52 offen offset:0 sc1
  v_pk_mul_f32 v[32:33], v[148:149], s[66:67]
  v_pk_mul_f32 v[34:35], v[150:151], s[66:67]
  v_pk_mul_f32 v[36:37], v[164:165], s[66:67]
  v_pk_mul_f32 v[38:39], v[166:167], s[66:67]
  v_exp_f32 v32, v32
  v_exp_f32 v33, v33
  v_exp_f32 v34, v34
  v_exp_f32 v35, v35
  v_exp_f32 v36, v36
  v_exp_f32 v37, v37
  v_exp_f32 v38, v38
  v_exp_f32 v39, v39
  v_pk_add_f32 v[32:33], v[32:33], s[68:69]
  v_pk_add_f32 v[34:35], v[34:35], s[68:69]
  v_pk_add_f32 v[36:37], v[36:37], s[68:69]
  v_pk_add_f32 v[38:39], v[38:39], s[68:69]
  v_rcp_f32 v32, v32
  v_rcp_f32 v33, v33
  v_rcp_f32 v34, v34
  v_rcp_f32 v35, v35
  v_rcp_f32 v36, v36
  v_rcp_f32 v37, v37
  v_rcp_f32 v38, v38
  v_rcp_f32 v39, v39
  v_pk_mul_f32 v[32:33], v[148:149], v[32:33]
  v_pk_mul_f32 v[34:35], v[150:151], v[34:35]
  v_pk_mul_f32 v[36:37], v[164:165], v[36:37]
  v_pk_mul_f32 v[38:39], v[166:167], v[38:39]
  v_cvt_pk_bf16_f32 v52, v32, v33
  v_cvt_pk_bf16_f32 v53, v34, v35
  v_cvt_pk_bf16_f32 v54, v36, v37
  v_cvt_pk_bf16_f32 v55, v38, v39
  ds_write_b128 v1, v[52:55] offset:1024
  buffer_store_dwordx4 v[52:55], v10, s[36:39], s52 offen offset:1024 sc1
  v_pk_mul_f32 v[16:17], v[152:153], s[66:67]
  v_pk_mul_f32 v[18:19], v[154:155], s[66:67]
  v_pk_mul_f32 v[20:21], v[168:169], s[66:67]
  v_pk_mul_f32 v[22:23], v[170:171], s[66:67]
  v_exp_f32 v16, v16
  v_exp_f32 v17, v17
  v_exp_f32 v18, v18
  v_exp_f32 v19, v19
  v_exp_f32 v20, v20
  v_exp_f32 v21, v21
  v_exp_f32 v22, v22
  v_exp_f32 v23, v23
  v_pk_add_f32 v[16:17], v[16:17], s[68:69]
  v_pk_add_f32 v[18:19], v[18:19], s[68:69]
  v_pk_add_f32 v[20:21], v[20:21], s[68:69]
  v_pk_add_f32 v[22:23], v[22:23], s[68:69]
  v_rcp_f32 v16, v16
  v_rcp_f32 v17, v17
  v_rcp_f32 v18, v18
  v_rcp_f32 v19, v19
  v_rcp_f32 v20, v20
  v_rcp_f32 v21, v21
  v_rcp_f32 v22, v22
  v_rcp_f32 v23, v23
  v_pk_mul_f32 v[16:17], v[152:153], v[16:17]
  v_pk_mul_f32 v[18:19], v[154:155], v[18:19]
  v_pk_mul_f32 v[20:21], v[168:169], v[20:21]
  v_pk_mul_f32 v[22:23], v[170:171], v[22:23]
  v_cvt_pk_bf16_f32 v56, v16, v17
  v_cvt_pk_bf16_f32 v57, v18, v19
  v_cvt_pk_bf16_f32 v58, v20, v21
  v_cvt_pk_bf16_f32 v59, v22, v23
  ds_write_b128 v1, v[56:59] offset:2048
  buffer_store_dwordx4 v[56:59], v10, s[36:39], s52 offen offset:2048 sc1
  v_pk_mul_f32 v[24:25], v[156:157], s[66:67]
  v_pk_mul_f32 v[26:27], v[158:159], s[66:67]
  v_pk_mul_f32 v[28:29], v[172:173], s[66:67]
  v_pk_mul_f32 v[30:31], v[174:175], s[66:67]
  v_exp_f32 v24, v24
  v_exp_f32 v25, v25
  v_exp_f32 v26, v26
  v_exp_f32 v27, v27
  v_exp_f32 v28, v28
  v_exp_f32 v29, v29
  v_exp_f32 v30, v30
  v_exp_f32 v31, v31
  v_pk_add_f32 v[24:25], v[24:25], s[68:69]
  v_pk_add_f32 v[26:27], v[26:27], s[68:69]
  v_pk_add_f32 v[28:29], v[28:29], s[68:69]
  v_pk_add_f32 v[30:31], v[30:31], s[68:69]
  v_rcp_f32 v24, v24
  v_rcp_f32 v25, v25
  v_rcp_f32 v26, v26
  v_rcp_f32 v27, v27
  v_rcp_f32 v28, v28
  v_rcp_f32 v29, v29
  v_rcp_f32 v30, v30
  v_rcp_f32 v31, v31
  v_pk_mul_f32 v[24:25], v[156:157], v[24:25]
  v_pk_mul_f32 v[26:27], v[158:159], v[26:27]
  v_pk_mul_f32 v[28:29], v[172:173], v[28:29]
  v_pk_mul_f32 v[30:31], v[174:175], v[30:31]
  v_cvt_pk_bf16_f32 v60, v24, v25
  v_cvt_pk_bf16_f32 v61, v26, v27
  v_cvt_pk_bf16_f32 v62, v28, v29
  v_cvt_pk_bf16_f32 v63, v30, v31
  ds_write_b128 v1, v[60:63] offset:3072
  buffer_store_dwordx4 v[60:63], v10, s[36:39], s52 offen offset:3072 sc1
  s_add_u32 s53, s62, 82944
  v_add_u32 v1, s53, v10
  s_add_u32 s52, s65, s62
  v_pk_mul_f32 v[32:33], v[176:177], s[66:67]
  v_pk_mul_f32 v[34:35], v[178:179], s[66:67]
  v_pk_mul_f32 v[36:37], v[192:193], s[66:67]
  v_pk_mul_f32 v[38:39], v[194:195], s[66:67]
  v_exp_f32 v32, v32
  v_exp_f32 v33, v33
  v_exp_f32 v34, v34
  v_exp_f32 v35, v35
  v_exp_f32 v36, v36
  v_exp_f32 v37, v37
  v_exp_f32 v38, v38
  v_exp_f32 v39, v39
  v_pk_add_f32 v[32:33], v[32:33], s[68:69]
  v_pk_add_f32 v[34:35], v[34:35], s[68:69]
  v_pk_add_f32 v[36:37], v[36:37], s[68:69]
  v_pk_add_f32 v[38:39], v[38:39], s[68:69]
  v_rcp_f32 v32, v32
  v_rcp_f32 v33, v33
  v_rcp_f32 v34, v34
  v_rcp_f32 v35, v35
  v_rcp_f32 v36, v36
  v_rcp_f32 v37, v37
  v_rcp_f32 v38, v38
  v_rcp_f32 v39, v39
  v_pk_mul_f32 v[32:33], v[176:177], v[32:33]
  v_pk_mul_f32 v[34:35], v[178:179], v[34:35]
  v_pk_mul_f32 v[36:37], v[192:193], v[36:37]
  v_pk_mul_f32 v[38:39], v[194:195], v[38:39]
  v_cvt_pk_bf16_f32 v48, v32, v33
  v_cvt_pk_bf16_f32 v49, v34, v35
  v_cvt_pk_bf16_f32 v50, v36, v37
  v_cvt_pk_bf16_f32 v51, v38, v39
  ds_write_b128 v1, v[48:51] offset:0
  buffer_store_dwordx4 v[48:51], v10, s[36:39], s52 offen offset:0 sc1
  v_pk_mul_f32 v[16:17], v[180:181], s[66:67]
  v_pk_mul_f32 v[18:19], v[182:183], s[66:67]
  v_pk_mul_f32 v[20:21], v[196:197], s[66:67]
  v_pk_mul_f32 v[22:23], v[198:199], s[66:67]
  v_exp_f32 v16, v16
  v_exp_f32 v17, v17
  v_exp_f32 v18, v18
  v_exp_f32 v19, v19
  v_exp_f32 v20, v20
  v_exp_f32 v21, v21
  v_exp_f32 v22, v22
  v_exp_f32 v23, v23
  v_pk_add_f32 v[16:17], v[16:17], s[68:69]
  v_pk_add_f32 v[18:19], v[18:19], s[68:69]
  v_pk_add_f32 v[20:21], v[20:21], s[68:69]
  v_pk_add_f32 v[22:23], v[22:23], s[68:69]
  v_rcp_f32 v16, v16
  v_rcp_f32 v17, v17
  v_rcp_f32 v18, v18
  v_rcp_f32 v19, v19
  v_rcp_f32 v20, v20
  v_rcp_f32 v21, v21
  v_rcp_f32 v22, v22
  v_rcp_f32 v23, v23
  v_pk_mul_f32 v[16:17], v[180:181], v[16:17]
  v_pk_mul_f32 v[18:19], v[182:183], v[18:19]
  v_pk_mul_f32 v[20:21], v[196:197], v[20:21]
  v_pk_mul_f32 v[22:23], v[198:199], v[22:23]
  v_cvt_pk_bf16_f32 v52, v16, v17
  v_cvt_pk_bf16_f32 v53, v18, v19
  v_cvt_pk_bf16_f32 v54, v20, v21
  v_cvt_pk_bf16_f32 v55, v22, v23
  ds_write_b128 v1, v[52:55] offset:1024
  buffer_store_dwordx4 v[52:55], v10, s[36:39], s52 offen offset:1024 sc1
  v_pk_mul_f32 v[24:25], v[184:185], s[66:67]
  v_pk_mul_f32 v[26:27], v[186:187], s[66:67]
  v_pk_mul_f32 v[28:29], v[200:201], s[66:67]
  v_pk_mul_f32 v[30:31], v[202:203], s[66:67]
  v_exp_f32 v24, v24
  v_exp_f32 v25, v25
  v_exp_f32 v26, v26
  v_exp_f32 v27, v27
  v_exp_f32 v28, v28
  v_exp_f32 v29, v29
  v_exp_f32 v30, v30
  v_exp_f32 v31, v31
  v_pk_add_f32 v[24:25], v[24:25], s[68:69]
  v_pk_add_f32 v[26:27], v[26:27], s[68:69]
  v_pk_add_f32 v[28:29], v[28:29], s[68:69]
  v_pk_add_f32 v[30:31], v[30:31], s[68:69]
  v_rcp_f32 v24, v24
  v_rcp_f32 v25, v25
  v_rcp_f32 v26, v26
  v_rcp_f32 v27, v27
  v_rcp_f32 v28, v28
  v_rcp_f32 v29, v29
  v_rcp_f32 v30, v30
  v_rcp_f32 v31, v31
  v_pk_mul_f32 v[24:25], v[184:185], v[24:25]
  v_pk_mul_f32 v[26:27], v[186:187], v[26:27]
  v_pk_mul_f32 v[28:29], v[200:201], v[28:29]
  v_pk_mul_f32 v[30:31], v[202:203], v[30:31]
  v_cvt_pk_bf16_f32 v56, v24, v25
  v_cvt_pk_bf16_f32 v57, v26, v27
  v_cvt_pk_bf16_f32 v58, v28, v29
  v_cvt_pk_bf16_f32 v59, v30, v31
  ds_write_b128 v1, v[56:59] offset:2048
  buffer_store_dwordx4 v[56:59], v10, s[36:39], s52 offen offset:2048 sc1
  v_pk_mul_f32 v[32:33], v[188:189], s[66:67]
  v_pk_mul_f32 v[34:35], v[190:191], s[66:67]
  v_pk_mul_f32 v[36:37], v[204:205], s[66:67]
  v_pk_mul_f32 v[38:39], v[206:207], s[66:67]
  v_exp_f32 v32, v32
  v_exp_f32 v33, v33
  v_exp_f32 v34, v34
  v_exp_f32 v35, v35
  v_exp_f32 v36, v36
  v_exp_f32 v37, v37
  v_exp_f32 v38, v38
  v_exp_f32 v39, v39
  v_pk_add_f32 v[32:33], v[32:33], s[68:69]
  v_pk_add_f32 v[34:35], v[34:35], s[68:69]
  v_pk_add_f32 v[36:37], v[36:37], s[68:69]
  v_pk_add_f32 v[38:39], v[38:39], s[68:69]
  v_rcp_f32 v32, v32
  v_rcp_f32 v33, v33
  v_rcp_f32 v34, v34
  v_rcp_f32 v35, v35
  v_rcp_f32 v36, v36
  v_rcp_f32 v37, v37
  v_rcp_f32 v38, v38
  v_rcp_f32 v39, v39
  v_pk_mul_f32 v[32:33], v[188:189], v[32:33]
  v_pk_mul_f32 v[34:35], v[190:191], v[34:35]
  v_pk_mul_f32 v[36:37], v[204:205], v[36:37]
  v_pk_mul_f32 v[38:39], v[206:207], v[38:39]
  v_cvt_pk_bf16_f32 v60, v32, v33
  v_cvt_pk_bf16_f32 v61, v34, v35
  v_cvt_pk_bf16_f32 v62, v36, v37
  v_cvt_pk_bf16_f32 v63, v38, v39
  ds_write_b128 v1, v[60:63] offset:3072
  buffer_store_dwordx4 v[60:63], v10, s[36:39], s52 offen offset:3072 sc1
  s_add_u32 s53, s63, 82944
  v_add_u32 v1, s53, v10
  s_add_u32 s52, s65, s63
  v_pk_mul_f32 v[16:17], v[208:209], s[66:67]
  v_pk_mul_f32 v[18:19], v[210:211], s[66:67]
  v_pk_mul_f32 v[20:21], v[224:225], s[66:67]
  v_pk_mul_f32 v[22:23], v[226:227], s[66:67]
  v_exp_f32 v16, v16
  v_exp_f32 v17, v17
  v_exp_f32 v18, v18
  v_exp_f32 v19, v19
  v_exp_f32 v20, v20
  v_exp_f32 v21, v21
  v_exp_f32 v22, v22
  v_exp_f32 v23, v23
  v_pk_add_f32 v[16:17], v[16:17], s[68:69]
  v_pk_add_f32 v[18:19], v[18:19], s[68:69]
  v_pk_add_f32 v[20:21], v[20:21], s[68:69]
  v_pk_add_f32 v[22:23], v[22:23], s[68:69]
  v_rcp_f32 v16, v16
  v_rcp_f32 v17, v17
  v_rcp_f32 v18, v18
  v_rcp_f32 v19, v19
  v_rcp_f32 v20, v20
  v_rcp_f32 v21, v21
  v_rcp_f32 v22, v22
  v_rcp_f32 v23, v23
  v_pk_mul_f32 v[16:17], v[208:209], v[16:17]
  v_pk_mul_f32 v[18:19], v[210:211], v[18:19]
  v_pk_mul_f32 v[20:21], v[224:225], v[20:21]
  v_pk_mul_f32 v[22:23], v[226:227], v[22:23]
  v_cvt_pk_bf16_f32 v48, v16, v17
  v_cvt_pk_bf16_f32 v49, v18, v19
  v_cvt_pk_bf16_f32 v50, v20, v21
  v_cvt_pk_bf16_f32 v51, v22, v23
  ds_write_b128 v1, v[48:51] offset:0
  buffer_store_dwordx4 v[48:51], v10, s[36:39], s52 offen offset:0 sc1
  v_pk_mul_f32 v[24:25], v[212:213], s[66:67]
  v_pk_mul_f32 v[26:27], v[214:215], s[66:67]
  v_pk_mul_f32 v[28:29], v[228:229], s[66:67]
  v_pk_mul_f32 v[30:31], v[230:231], s[66:67]
  v_exp_f32 v24, v24
  v_exp_f32 v25, v25
  v_exp_f32 v26, v26
  v_exp_f32 v27, v27
  v_exp_f32 v28, v28
  v_exp_f32 v29, v29
  v_exp_f32 v30, v30
  v_exp_f32 v31, v31
  v_pk_add_f32 v[24:25], v[24:25], s[68:69]
  v_pk_add_f32 v[26:27], v[26:27], s[68:69]
  v_pk_add_f32 v[28:29], v[28:29], s[68:69]
  v_pk_add_f32 v[30:31], v[30:31], s[68:69]
  v_rcp_f32 v24, v24
  v_rcp_f32 v25, v25
  v_rcp_f32 v26, v26
  v_rcp_f32 v27, v27
  v_rcp_f32 v28, v28
  v_rcp_f32 v29, v29
  v_rcp_f32 v30, v30
  v_rcp_f32 v31, v31
  v_pk_mul_f32 v[24:25], v[212:213], v[24:25]
  v_pk_mul_f32 v[26:27], v[214:215], v[26:27]
  v_pk_mul_f32 v[28:29], v[228:229], v[28:29]
  v_pk_mul_f32 v[30:31], v[230:231], v[30:31]
  v_cvt_pk_bf16_f32 v52, v24, v25
  v_cvt_pk_bf16_f32 v53, v26, v27
  v_cvt_pk_bf16_f32 v54, v28, v29
  v_cvt_pk_bf16_f32 v55, v30, v31
  ds_write_b128 v1, v[52:55] offset:1024
  buffer_store_dwordx4 v[52:55], v10, s[36:39], s52 offen offset:1024 sc1
  v_pk_mul_f32 v[32:33], v[216:217], s[66:67]
  v_pk_mul_f32 v[34:35], v[218:219], s[66:67]
  v_pk_mul_f32 v[36:37], v[232:233], s[66:67]
  v_pk_mul_f32 v[38:39], v[234:235], s[66:67]
  v_exp_f32 v32, v32
  v_exp_f32 v33, v33
  v_exp_f32 v34, v34
  v_exp_f32 v35, v35
  v_exp_f32 v36, v36
  v_exp_f32 v37, v37
  v_exp_f32 v38, v38
  v_exp_f32 v39, v39
  v_pk_add_f32 v[32:33], v[32:33], s[68:69]
  v_pk_add_f32 v[34:35], v[34:35], s[68:69]
  v_pk_add_f32 v[36:37], v[36:37], s[68:69]
  v_pk_add_f32 v[38:39], v[38:39], s[68:69]
  v_rcp_f32 v32, v32
  v_rcp_f32 v33, v33
  v_rcp_f32 v34, v34
  v_rcp_f32 v35, v35
  v_rcp_f32 v36, v36
  v_rcp_f32 v37, v37
  v_rcp_f32 v38, v38
  v_rcp_f32 v39, v39
  v_pk_mul_f32 v[32:33], v[216:217], v[32:33]
  v_pk_mul_f32 v[34:35], v[218:219], v[34:35]
  v_pk_mul_f32 v[36:37], v[232:233], v[36:37]
  v_pk_mul_f32 v[38:39], v[234:235], v[38:39]
  v_cvt_pk_bf16_f32 v56, v32, v33
  v_cvt_pk_bf16_f32 v57, v34, v35
  v_cvt_pk_bf16_f32 v58, v36, v37
  v_cvt_pk_bf16_f32 v59, v38, v39
  ds_write_b128 v1, v[56:59] offset:2048
  buffer_store_dwordx4 v[56:59], v10, s[36:39], s52 offen offset:2048 sc1
  v_pk_mul_f32 v[16:17], v[220:221], s[66:67]
  v_pk_mul_f32 v[18:19], v[222:223], s[66:67]
  v_pk_mul_f32 v[20:21], v[236:237], s[66:67]
  v_pk_mul_f32 v[22:23], v[238:239], s[66:67]
  v_exp_f32 v16, v16
  v_exp_f32 v17, v17
  v_exp_f32 v18, v18
  v_exp_f32 v19, v19
  v_exp_f32 v20, v20
  v_exp_f32 v21, v21
  v_exp_f32 v22, v22
  v_exp_f32 v23, v23
  v_pk_add_f32 v[16:17], v[16:17], s[68:69]
  v_pk_add_f32 v[18:19], v[18:19], s[68:69]
  v_pk_add_f32 v[20:21], v[20:21], s[68:69]
  v_pk_add_f32 v[22:23], v[22:23], s[68:69]
  v_rcp_f32 v16, v16
  v_rcp_f32 v17, v17
  v_rcp_f32 v18, v18
  v_rcp_f32 v19, v19
  v_rcp_f32 v20, v20
  v_rcp_f32 v21, v21
  v_rcp_f32 v22, v22
  v_rcp_f32 v23, v23
  v_pk_mul_f32 v[16:17], v[220:221], v[16:17]
  v_pk_mul_f32 v[18:19], v[222:223], v[18:19]
  v_pk_mul_f32 v[20:21], v[236:237], v[20:21]
  v_pk_mul_f32 v[22:23], v[238:239], v[22:23]
  v_cvt_pk_bf16_f32 v60, v16, v17
  v_cvt_pk_bf16_f32 v61, v18, v19
  v_cvt_pk_bf16_f32 v62, v20, v21
  v_cvt_pk_bf16_f32 v63, v22, v23
  ds_write_b128 v1, v[60:63] offset:3072
  buffer_store_dwordx4 v[60:63], v10, s[36:39], s52 offen offset:3072 sc1
  s_add_u32 s53, s64, 82944
  v_add_u32 v1, s53, v10
  s_add_u32 s52, s65, s64
  v_pk_mul_f32 v[24:25], v[240:241], s[66:67]
  v_pk_mul_f32 v[26:27], v[242:243], s[66:67]
  v_exp_f32 v24, v24
  v_exp_f32 v25, v25
  v_exp_f32 v26, v26
  v_exp_f32 v27, v27
  v_pk_add_f32 v[24:25], v[24:25], s[68:69]
  v_pk_add_f32 v[26:27], v[26:27], s[68:69]
  v_rcp_f32 v24, v24
  v_rcp_f32 v25, v25
  v_rcp_f32 v26, v26
  v_rcp_f32 v27, v27
  v_pk_mul_f32 v[24:25], v[240:241], v[24:25]
  v_pk_mul_f32 v[26:27], v[242:243], v[26:27]
  v_cvt_pk_bf16_f32 v48, v24, v25
  v_cvt_pk_bf16_f32 v49, v26, v27
  ds_write_b64 v1, v[48:49] offset:0
  buffer_store_dwordx2 v[48:49], v10, s[36:39], s52 offen offset:0 sc1
  v_pk_mul_f32 v[32:33], v[244:245], s[66:67]
  v_pk_mul_f32 v[34:35], v[246:247], s[66:67]
  v_exp_f32 v32, v32
  v_exp_f32 v33, v33
  v_exp_f32 v34, v34
  v_exp_f32 v35, v35
  v_pk_add_f32 v[32:33], v[32:33], s[68:69]
  v_pk_add_f32 v[34:35], v[34:35], s[68:69]
  v_rcp_f32 v32, v32
  v_rcp_f32 v33, v33
  v_rcp_f32 v34, v34
  v_rcp_f32 v35, v35
  v_pk_mul_f32 v[32:33], v[244:245], v[32:33]
  v_pk_mul_f32 v[34:35], v[246:247], v[34:35]
  v_cvt_pk_bf16_f32 v52, v32, v33
  v_cvt_pk_bf16_f32 v53, v34, v35
  ds_write_b64 v1, v[52:53] offset:1024
  buffer_store_dwordx2 v[52:53], v10, s[36:39], s52 offen offset:1024 sc1
  v_pk_mul_f32 v[16:17], v[248:249], s[66:67]
  v_pk_mul_f32 v[18:19], v[250:251], s[66:67]
  v_exp_f32 v16, v16
  v_exp_f32 v17, v17
  v_exp_f32 v18, v18
  v_exp_f32 v19, v19
  v_pk_add_f32 v[16:17], v[16:17], s[68:69]
  v_pk_add_f32 v[18:19], v[18:19], s[68:69]
  v_rcp_f32 v16, v16
  v_rcp_f32 v17, v17
  v_rcp_f32 v18, v18
  v_rcp_f32 v19, v19
  v_pk_mul_f32 v[16:17], v[248:249], v[16:17]
  v_pk_mul_f32 v[18:19], v[250:251], v[18:19]
  v_cvt_pk_bf16_f32 v56, v16, v17
  v_cvt_pk_bf16_f32 v57, v18, v19
  ds_write_b64 v1, v[56:57] offset:2048
  buffer_store_dwordx2 v[56:57], v10, s[36:39], s52 offen offset:2048 sc1
  v_pk_mul_f32 v[24:25], v[252:253], s[66:67]
  v_pk_mul_f32 v[26:27], v[254:255], s[66:67]
  v_exp_f32 v24, v24
  v_exp_f32 v25, v25
  v_exp_f32 v26, v26
  v_exp_f32 v27, v27
  v_pk_add_f32 v[24:25], v[24:25], s[68:69]
  v_pk_add_f32 v[26:27], v[26:27], s[68:69]
  v_rcp_f32 v24, v24
  v_rcp_f32 v25, v25
  v_rcp_f32 v26, v26
  v_rcp_f32 v27, v27
  v_pk_mul_f32 v[24:25], v[252:253], v[24:25]
  v_pk_mul_f32 v[26:27], v[254:255], v[26:27]
  v_cvt_pk_bf16_f32 v60, v24, v25
  v_cvt_pk_bf16_f32 v61, v26, v27
  ds_write_b64 v1, v[60:61] offset:3072
  buffer_store_dwordx2 v[60:61], v10, s[36:39], s52 offen offset:3072 sc1
  s_mov_b32 s55, s51
  s_mov_b32 s57, 8
  s_waitcnt lgkmcnt(0)
  s_barrier
  ds_read_b128 v[52:55], v7 offset:0
  ds_read_b128 v[56:59], v7 offset:1024
  ds_read_b128 v[60:63], v8 offset:0
  ds_read_b128 v[64:67], v8 offset:1024
  ds_read_b64_tr_b16 v[16:17], v9 offset:0
  ds_read_b64_tr_b16 v[18:19], v9 offset:4608
  ds_read_b64_tr_b16 v[20:21], v9 offset:32
  ds_read_b64_tr_b16 v[22:23], v9 offset:4640
  ds_read_b64_tr_b16 v[24:25], v9 offset:64
  ds_read_b64_tr_b16 v[26:27], v9 offset:4672
  ds_read_b64_tr_b16 v[28:29], v9 offset:96
  ds_read_b64_tr_b16 v[30:31], v9 offset:4704
  ds_read_b64_tr_b16 v[32:33], v9 offset:128
  ds_read_b64_tr_b16 v[34:35], v9 offset:4736
  ds_read_b64_tr_b16 v[36:37], v9 offset:160
  ds_read_b64_tr_b16 v[38:39], v9 offset:4768
  ds_read_b64_tr_b16 v[40:41], v9 offset:192
  ds_read_b64_tr_b16 v[42:43], v9 offset:4800
  ds_read_b64_tr_b16 v[44:45], v9 offset:224
  ds_read_b64_tr_b16 v[46:47], v9 offset:4832
  s_waitcnt lgkmcnt(14)
  v_mfma_f32_16x16x32_bf16 v[112:115], v[16:19], v[52:55], 0
  ds_read_b64_tr_b16 v[48:49], v9 offset:256
  v_mfma_f32_16x16x32_bf16 v[116:119], v[16:19], v[56:59], 0
  ds_read_b64_tr_b16 v[50:51], v9 offset:4864
  v_mfma_f32_16x16x32_bf16 v[120:123], v[16:19], v[60:63], 0
  s_add_u32 s55, s55, 2
  s_cmp_ge_u32 s55, 9
  s_cselect_b32 s58, s73, s72
  s_cselect_b32 s59, s75, s74
  s_cselect_b32 s52, 9, 0
  s_sub_u32 s55, s55, s52
  v_mfma_f32_16x16x32_bf16 v[124:127], v[16:19], v[64:67], 0
  v_add_u32 v9, s59, v9
  s_waitcnt lgkmcnt(14)
  v_mfma_f32_16x16x32_bf16 v[128:131], v[20:23], v[52:55], 0
  v_add_u32 v7, s58, v7
  v_mfma_f32_16x16x32_bf16 v[132:135], v[20:23], v[56:59], 0
  v_add_u32 v8, s58, v8
  v_mfma_f32_16x16x32_bf16 v[136:139], v[20:23], v[60:63], 0
  v_mfma_f32_16x16x32_bf16 v[140:143], v[20:23], v[64:67], 0
  s_waitcnt lgkmcnt(12)
  v_mfma_f32_16x16x32_bf16 v[144:147], v[24:27], v[52:55], 0
  v_mfma_f32_16x16x32_bf16 v[148:151], v[24:27], v[56:59], 0
  v_mfma_f32_16x16x32_bf16 v[152:155], v[24:27], v[60:63], 0
  v_mfma_f32_16x16x32_bf16 v[156:159], v[24:27], v[64:67], 0
  s_waitcnt lgkmcnt(0)
  s_waitcnt vmcnt(0)
  s_barrier
  s_waitcnt lgkmcnt(15)
  v_mfma_f32_16x16x32_bf16 v[160:163], v[28:31], v[52:55], 0
  ds_read_b128 v[68:71], v7 offset:0
  v_mfma_f32_16x16x32_bf16 v[164:167], v[28:31], v[56:59], 0
  ds_read_b128 v[72:75], v7 offset:1024
  v_mfma_f32_16x16x32_bf16 v[168:171], v[28:31], v[60:63], 0
  ds_read_b128 v[76:79], v8 offset:0
  v_mfma_f32_16x16x32_bf16 v[172:175], v[28:31], v[64:67], 0
  ds_read_b128 v[80:83], v8 offset:1024
  s_waitcnt lgkmcnt(15)
  v_mfma_f32_16x16x32_bf16 v[176:179], v[32:35], v[52:55], 0
  ds_read_b64_tr_b16 v[16:17], v9 offset:0
  v_mfma_f32_16x16x32_bf16 v[180:183], v[32:35], v[56:59], 0
  ds_read_b64_tr_b16 v[18:19], v9 offset:4608
  v_mfma_f32_16x16x32_bf16 v[184:187], v[32:35], v[60:63], 0
  ds_read_b64_tr_b16 v[20:21], v9 offset:32
  v_mfma_f32_16x16x32_bf16 v[188:191], v[32:35], v[64:67], 0
  ds_read_b64_tr_b16 v[22:23], v9 offset:4640
  s_waitcnt lgkmcnt(15)
  v_mfma_f32_16x16x32_bf16 v[192:195], v[36:39], v[52:55], 0
  ds_read_b64_tr_b16 v[24:25], v9 offset:64
  v_mfma_f32_16x16x32_bf16 v[196:199], v[36:39], v[56:59], 0
  ds_read_b64_tr_b16 v[26:27], v9 offset:4672
  v_mfma_f32_16x16x32_bf16 v[200:203], v[36:39], v[60:63], 0
  ds_read_b64_tr_b16 v[28:29], v9 offset:96
  v_mfma_f32_16x16x32_bf16 v[204:207], v[36:39], v[64:67], 0
  ds_read_b64_tr_b16 v[30:31], v9 offset:4704
  s_waitcnt lgkmcnt(15)
  v_mfma_f32_16x16x32_bf16 v[208:211], v[40:43], v[52:55], 0
  ds_read_b64_tr_b16 v[32:33], v9 offset:128
  v_mfma_f32_16x16x32_bf16 v[212:215], v[40:43], v[56:59], 0
  ds_read_b64_tr_b16 v[34:35], v9 offset:4736
  v_mfma_f32_16x16x32_bf16 v[216:219], v[40:43], v[60:63], 0
  ds_read_b64_tr_b16 v[36:37], v9 offset:160
  v_mfma_f32_16x16x32_bf16 v[220:223], v[40:43], v[64:67], 0
  ds_read_b64_tr_b16 v[38:39], v9 offset:4768
  s_waitcnt lgkmcnt(15)
  v_mfma_f32_16x16x32_bf16 v[224:227], v[44:47], v[52:55], 0
  ds_read_b64_tr_b16 v[40:41], v9 offset:192
  v_mfma_f32_16x16x32_bf16 v[228:231], v[44:47], v[56:59], 0
  ds_read_b64_tr_b16 v[42:43], v9 offset:4800
  v_mfma_f32_16x16x32_bf16 v[232:235], v[44:47], v[60:63], 0
  v_mfma_f32_16x16x32_bf16 v[236:239], v[44:47], v[64:67], 0
  s_waitcnt lgkmcnt(15)
  v_mfma_f32_16x16x32_bf16 v[240:243], v[48:51], v[52:55], 0
  ds_read_b64_tr_b16 v[44:45], v9 offset:224
  v_mfma_f32_16x16x32_bf16 v[244:247], v[48:51], v[56:59], 0
  ds_read_b64_tr_b16 v[46:47], v9 offset:4832
  v_mfma_f32_16x16x32_bf16 v[248:251], v[48:51], v[60:63], 0
  v_mfma_f32_16x16x32_bf16 v[252:255], v[48:51], v[64:67], 0
L_p2_loop:
  s_waitcnt lgkmcnt(14)
  v_mfma_f32_16x16x32_bf16 v[112:115], v[16:19], v[68:71], v[112:115]
  ds_read_b64_tr_b16 v[48:49], v9 offset:256
  v_mfma_f32_16x16x32_bf16 v[116:119], v[16:19], v[72:75], v[116:119]
  ds_read_b64_tr_b16 v[50:51], v9 offset:4864
  v_mfma_f32_16x16x32_bf16 v[120:123], v[16:19], v[76:79], v[120:123]
  s_add_u32 s55, s55, 2
  s_cmp_ge_u32 s55, 9
  s_cselect_b32 s58, s73, s72
  s_cselect_b32 s59, s75, s74
  s_cselect_b32 s52, 9, 0
  s_sub_u32 s55, s55, s52
  v_mfma_f32_16x16x32_bf16 v[124:127], v[16:19], v[80:83], v[124:127]
  v_add_u32 v9, s59, v9
  s_waitcnt lgkmcnt(14)
  v_mfma_f32_16x16x32_bf16 v[128:131], v[20:23], v[68:71], v[128:131]
  v_add_u32 v7, s58, v7
  v_mfma_f32_16x16x32_bf16 v[132:135], v[20:23], v[72:75], v[132:135]
  v_add_u32 v8, s58, v8
  v_mfma_f32_16x16x32_bf16 v[136:139], v[20:23], v[76:79], v[136:139]
  v_mfma_f32_16x16x32_bf16 v[140:143], v[20:23], v[80:83], v[140:143]
  s_waitcnt lgkmcnt(12)
  v_mfma_f32_16x16x32_bf16 v[144:147], v[24:27], v[68:71], v[144:147]
  v_mfma_f32_16x16x32_bf16 v[148:151], v[24:27], v[72:75], v[148:151]
  v_mfma_f32_16x16x32_bf16 v[152:155], v[24:27], v[76:79], v[152:155]
  v_mfma_f32_16x16x32_bf16 v[156:159], v[24:27], v[80:83], v[156:159]
  s_waitcnt lgkmcnt(0)
  s_barrier
  s_waitcnt lgkmcnt(15)
  v_mfma_f32_16x16x32_bf16 v[160:163], v[28:31], v[68:71], v[160:163]
  ds_read_b128 v[52:55], v7 offset:0
  v_mfma_f32_16x16x32_bf16 v[164:167], v[28:31], v[72:75], v[164:167]
  ds_read_b128 v[56:59], v7 offset:1024
  v_mfma_f32_16x16x32_bf16 v[168:171], v[28:31], v[76:79], v[168:171]
  ds_read_b128 v[60:63], v8 offset:0
  v_mfma_f32_16x16x32_bf16 v[172:175], v[28:31], v[80:83], v[172:175]
  ds_read_b128 v[64:67], v8 offset:1024
  s_waitcnt lgkmcnt(15)
  v_mfma_f32_16x16x32_bf16 v[176:179], v[32:35], v[68:71], v[176:179]
  ds_read_b64_tr_b16 v[16:17], v9 offset:0
  v_mfma_f32_16x16x32_bf16 v[180:183], v[32:35], v[72:75], v[180:183]
  ds_read_b64_tr_b16 v[18:19], v9 offset:4608
  v_mfma_f32_16x16x32_bf16 v[184:187], v[32:35], v[76:79], v[184:187]
  ds_read_b64_tr_b16 v[20:21], v9 offset:32
  v_mfma_f32_16x16x32_bf16 v[188:191], v[32:35], v[80:83], v[188:191]
  ds_read_b64_tr_b16 v[22:23], v9 offset:4640
  s_waitcnt lgkmcnt(15)
  v_mfma_f32_16x16x32_bf16 v[192:195], v[36:39], v[68:71], v[192:195]
  ds_read_b64_tr_b16 v[24:25], v9 offset:64
  v_mfma_f32_16x16x32_bf16 v[196:199], v[36:39], v[72:75], v[196:199]
  ds_read_b64_tr_b16 v[26:27], v9 offset:4672
  v_mfma_f32_16x16x32_bf16 v[200:203], v[36:39], v[76:79], v[200:203]
  ds_read_b64_tr_b16 v[28:29], v9 offset:96
  v_mfma_f32_16x16x32_bf16 v[204:207], v[36:39], v[80:83], v[204:207]
  ds_read_b64_tr_b16 v[30:31], v9 offset:4704
  s_waitcnt lgkmcnt(15)
  v_mfma_f32_16x16x32_bf16 v[208:211], v[40:43], v[68:71], v[208:211]
  ds_read_b64_tr_b16 v[32:33], v9 offset:128
  v_mfma_f32_16x16x32_bf16 v[212:215], v[40:43], v[72:75], v[212:215]
  ds_read_b64_tr_b16 v[34:35], v9 offset:4736
  v_mfma_f32_16x16x32_bf16 v[216:219], v[40:43], v[76:79], v[216:219]
  ds_read_b64_tr_b16 v[36:37], v9 offset:160
  v_mfma_f32_16x16x32_bf16 v[220:223], v[40:43], v[80:83], v[220:223]
  ds_read_b64_tr_b16 v[38:39], v9 offset:4768
  s_waitcnt lgkmcnt(15)
  v_mfma_f32_16x16x32_bf16 v[224:227], v[44:47], v[68:71], v[224:227]
  ds_read_b64_tr_b16 v[40:41], v9 offset:192
  v_mfma_f32_16x16x32_bf16 v[228:231], v[44:47], v[72:75], v[228:231]
  ds_read_b64_tr_b16 v[42:43], v9 offset:4800
  v_mfma_f32_16x16x32_bf16 v[232:235], v[44:47], v[76:79], v[232:235]
  v_mfma_f32_16x16x32_bf16 v[236:239], v[44:47], v[80:83], v[236:239]
  s_waitcnt lgkmcnt(15)
  v_mfma_f32_16x16x32_bf16 v[240:243], v[48:51], v[68:71], v[240:243]
  ds_read_b64_tr_b16 v[44:45], v9 offset:224
  v_mfma_f32_16x16x32_bf16 v[244:247], v[48:51], v[72:75], v[244:247]
  ds_read_b64_tr_b16 v[46:47], v9 offset:4832
  v_mfma_f32_16x16x32_bf16 v[248:251], v[48:51], v[76:79], v[248:251]
  v_mfma_f32_16x16x32_bf16 v[252:255], v[48:51], v[80:83], v[252:255]
  s_waitcnt lgkmcnt(14)
  v_mfma_f32_16x16x32_bf16 v[112:115], v[16:19], v[52:55], v[112:115]
  ds_read_b64_tr_b16 v[48:49], v9 offset:256
  v_mfma_f32_16x16x32_bf16 v[116:119], v[16:19], v[56:59], v[116:119]
  ds_read_b64_tr_b16 v[50:51], v9 offset:4864
  v_mfma_f32_16x16x32_bf16 v[120:123], v[16:19], v[60:63], v[120:123]
  s_add_u32 s55, s55, 2
  s_cmp_ge_u32 s55, 9
  s_cselect_b32 s58, s73, s72
  s_cselect_b32 s59, s75, s74
  s_cselect_b32 s52, 9, 0
  s_sub_u32 s55, s55, s52
  v_mfma_f32_16x16x32_bf16 v[124:127], v[16:19], v[64:67], v[124:127]
  v_add_u32 v9, s59, v9
  s_waitcnt lgkmcnt(14)
  v_mfma_f32_16x16x32_bf16 v[128:131], v[20:23], v[52:55], v[128:131]
  v_add_u32 v7, s58, v7
  v_mfma_f32_16x16x32_bf16 v[132:135], v[20:23], v[56:59], v[132:135]
  v_add_u32 v8, s58, v8
  v_mfma_f32_16x16x32_bf16 v[136:139], v[20:23], v[60:63], v[136:139]
  v_mfma_f32_16x16x32_bf16 v[140:143], v[20:23], v[64:67], v[140:143]
  s_waitcnt lgkmcnt(12)
  v_mfma_f32_16x16x32_bf16 v[144:147], v[24:27], v[52:55], v[144:147]
  v_mfma_f32_16x16x32_bf16 v[148:151], v[24:27], v[56:59], v[148:151]
  v_mfma_f32_16x16x32_bf16 v[152:155], v[24:27], v[60:63], v[152:155]
  v_mfma_f32_16x16x32_bf16 v[156:159], v[24:27], v[64:67], v[156:159]
  s_waitcnt lgkmcnt(0)
  s_barrier
  s_waitcnt lgkmcnt(15)
  v_mfma_f32_16x16x32_bf16 v[160:163], v[28:31], v[52:55], v[160:163]
  ds_read_b128 v[68:71], v7 offset:0
  v_mfma_f32_16x16x32_bf16 v[164:167], v[28:31], v[56:59], v[164:167]
  ds_read_b128 v[72:75], v7 offset:1024
  v_mfma_f32_16x16x32_bf16 v[168:171], v[28:31], v[60:63], v[168:171]
  ds_read_b128 v[76:79], v8 offset:0
  v_mfma_f32_16x16x32_bf16 v[172:175], v[28:31], v[64:67], v[172:175]
  ds_read_b128 v[80:83], v8 offset:1024
  s_waitcnt lgkmcnt(15)
  v_mfma_f32_16x16x32_bf16 v[176:179], v[32:35], v[52:55], v[176:179]
  ds_read_b64_tr_b16 v[16:17], v9 offset:0
  v_mfma_f32_16x16x32_bf16 v[180:183], v[32:35], v[56:59], v[180:183]
  ds_read_b64_tr_b16 v[18:19], v9 offset:4608
  v_mfma_f32_16x16x32_bf16 v[184:187], v[32:35], v[60:63], v[184:187]
  ds_read_b64_tr_b16 v[20:21], v9 offset:32
  v_mfma_f32_16x16x32_bf16 v[188:191], v[32:35], v[64:67], v[188:191]
  ds_read_b64_tr_b16 v[22:23], v9 offset:4640
  s_waitcnt lgkmcnt(15)
  v_mfma_f32_16x16x32_bf16 v[192:195], v[36:39], v[52:55], v[192:195]
  ds_read_b64_tr_b16 v[24:25], v9 offset:64
  v_mfma_f32_16x16x32_bf16 v[196:199], v[36:39], v[56:59], v[196:199]
  ds_read_b64_tr_b16 v[26:27], v9 offset:4672
  v_mfma_f32_16x16x32_bf16 v[200:203], v[36:39], v[60:63], v[200:203]
  ds_read_b64_tr_b16 v[28:29], v9 offset:96
  v_mfma_f32_16x16x32_bf16 v[204:207], v[36:39], v[64:67], v[204:207]
  ds_read_b64_tr_b16 v[30:31], v9 offset:4704
  s_waitcnt lgkmcnt(15)
  v_mfma_f32_16x16x32_bf16 v[208:211], v[40:43], v[52:55], v[208:211]
  ds_read_b64_tr_b16 v[32:33], v9 offset:128
  v_mfma_f32_16x16x32_bf16 v[212:215], v[40:43], v[56:59], v[212:215]
  ds_read_b64_tr_b16 v[34:35], v9 offset:4736
  v_mfma_f32_16x16x32_bf16 v[216:219], v[40:43], v[60:63], v[216:219]
  ds_read_b64_tr_b16 v[36:37], v9 offset:160
  v_mfma_f32_16x16x32_bf16 v[220:223], v[40:43], v[64:67], v[220:223]
  ds_read_b64_tr_b16 v[38:39], v9 offset:4768
  s_waitcnt lgkmcnt(15)
  v_mfma_f32_16x16x32_bf16 v[224:227], v[44:47], v[52:55], v[224:227]
  ds_read_b64_tr_b16 v[40:41], v9 offset:192
  v_mfma_f32_16x16x32_bf16 v[228:231], v[44:47], v[56:59], v[228:231]
  ds_read_b64_tr_b16 v[42:43], v9 offset:4800
  v_mfma_f32_16x16x32_bf16 v[232:235], v[44:47], v[60:63], v[232:235]
  v_mfma_f32_16x16x32_bf16 v[236:239], v[44:47], v[64:67], v[236:239]
  s_waitcnt lgkmcnt(15)
  v_mfma_f32_16x16x32_bf16 v[240:243], v[48:51], v[52:55], v[240:243]
  ds_read_b64_tr_b16 v[44:45], v9 offset:224
  v_mfma_f32_16x16x32_bf16 v[244:247], v[48:51], v[56:59], v[244:247]
  ds_read_b64_tr_b16 v[46:47], v9 offset:4832
  v_mfma_f32_16x16x32_bf16 v[248:251], v[48:51], v[60:63], v[248:251]
  v_mfma_f32_16x16x32_bf16 v[252:255], v[48:51], v[64:67], v[252:255]
  s_sub_u32 s57, s57, 1
  s_cmp_lg_u32 s57, 0
  s_cbranch_scc1 L_p2_loop
  s_mul_i32 s52, s43, 18432
  s_cmp_eq_u32 s43, 3
  s_cselect_b32 s53, 27648, 0
  s_add_u32 s52, s52, s53
  v_add_u32 v1, s52, v10
  s_xor_b32 s54, s43, 1
  s_mul_i32 s52, s54, 18432
  s_cmp_eq_u32 s54, 3
  s_cselect_b32 s53, 27648, 0
  s_add_u32 s52, s52, s53
  v_add_u32 v2, s52, v10
  v_add_u32 v3, 101376, v10
  s_waitcnt lgkmcnt(14)
  v_mfma_f32_16x16x32_bf16 v[120:123], v[16:19], v[76:79], v[120:123]
  ds_read_b64_tr_b16 v[48:49], v9 offset:256
  v_mfma_f32_16x16x32_bf16 v[124:127], v[16:19], v[80:83], v[124:127]
  ds_read_b64_tr_b16 v[50:51], v9 offset:4864
  s_waitcnt lgkmcnt(14)
  v_mfma_f32_16x16x32_bf16 v[136:139], v[20:23], v[76:79], v[136:139]
  v_mfma_f32_16x16x32_bf16 v[140:143], v[20:23], v[80:83], v[140:143]
  s_waitcnt lgkmcnt(12)
  v_mfma_f32_16x16x32_bf16 v[152:155], v[24:27], v[76:79], v[152:155]
  v_mfma_f32_16x16x32_bf16 v[156:159], v[24:27], v[80:83], v[156:159]
  s_waitcnt lgkmcnt(10)
  v_mfma_f32_16x16x32_bf16 v[168:171], v[28:31], v[76:79], v[168:171]
  v_mfma_f32_16x16x32_bf16 v[172:175], v[28:31], v[80:83], v[172:175]
  s_waitcnt lgkmcnt(8)
  v_mfma_f32_16x16x32_bf16 v[184:187], v[32:35], v[76:79], v[184:187]
  v_mfma_f32_16x16x32_bf16 v[188:191], v[32:35], v[80:83], v[188:191]
  s_waitcnt lgkmcnt(6)
  v_mfma_f32_16x16x32_bf16 v[200:203], v[36:39], v[76:79], v[200:203]
  v_mfma_f32_16x16x32_bf16 v[204:207], v[36:39], v[80:83], v[204:207]
  s_waitcnt lgkmcnt(4)
  v_mfma_f32_16x16x32_bf16 v[216:219], v[40:43], v[76:79], v[216:219]
  v_mfma_f32_16x16x32_bf16 v[220:223], v[40:43], v[80:83], v[220:223]
  s_waitcnt lgkmcnt(2)
  v_mfma_f32_16x16x32_bf16 v[232:235], v[44:47], v[76:79], v[232:235]
  v_mfma_f32_16x16x32_bf16 v[236:239], v[44:47], v[80:83], v[236:239]
  s_waitcnt lgkmcnt(0)
  v_mfma_f32_16x16x32_bf16 v[248:251], v[48:51], v[76:79], v[248:251]
  v_mfma_f32_16x16x32_bf16 v[252:255], v[48:51], v[80:83], v[252:255]
  v_mfma_f32_16x16x32_bf16 v[112:115], v[16:19], v[68:71], v[112:115]
  ds_write_b128 v1, v[120:123] offset:0
  ds_write_b128 v1, v[124:127] offset:1024
  v_mfma_f32_16x16x32_bf16 v[116:119], v[16:19], v[72:75], v[116:119]
  ds_write_b128 v1, v[136:139] offset:2048
  ds_write_b128 v1, v[140:143] offset:3072
  v_mfma_f32_16x16x32_bf16 v[128:131], v[20:23], v[68:71], v[128:131]
  ds_write_b128 v1, v[152:155] offset:4096
  ds_write_b128 v1, v[156:159] offset:5120
  v_mfma_f32_16x16x32_bf16 v[132:135], v[20:23], v[72:75], v[132:135]
  ds_write_b128 v1, v[168:171] offset:6144
  ds_write_b128 v1, v[172:175] offset:7168
  v_mfma_f32_16x16x32_bf16 v[144:147], v[24:27], v[68:71], v[144:147]
  ds_write_b128 v1, v[184:187] offset:8192
  ds_write_b128 v1, v[188:191] offset:9216
  v_mfma_f32_16x16x32_bf16 v[148:151], v[24:27], v[72:75], v[148:151]
  ds_write_b128 v1, v[200:203] offset:10240
  ds_write_b128 v1, v[204:207] offset:11264
  v_mfma_f32_16x16x32_bf16 v[160:163], v[28:31], v[68:71], v[160:163]
  ds_write_b128 v1, v[216:219] offset:12288
  ds_write_b128 v1, v[220:223] offset:13312
  v_mfma_f32_16x16x32_bf16 v[164:167], v[28:31], v[72:75], v[164:167]
  ds_write_b128 v1, v[232:235] offset:14336
  ds_write_b128 v1, v[236:239] offset:15360
  v_mfma_f32_16x16x32_bf16 v[176:179], v[32:35], v[68:71], v[176:179]
  ds_write_b128 v1, v[248:251] offset:16384
  ds_write_b128 v1, v[252:255] offset:17408
  s_waitcnt lgkmcnt(0)
  s_barrier
  v_mfma_f32_16x16x32_bf16 v[180:183], v[32:35], v[72:75], v[180:183]
  ds_read_b128 v[120:123], v2 offset:0
  ds_read_b128 v[124:127], v2 offset:1024
  v_mfma_f32_16x16x32_bf16 v[192:195], v[36:39], v[68:71], v[192:195]
  ds_read_b128 v[136:139], v2 offset:2048
  ds_read_b128 v[140:143], v2 offset:3072
  v_mfma_f32_16x16x32_bf16 v[196:199], v[36:39], v[72:75], v[196:199]
  ds_read_b128 v[152:155], v2 offset:4096
  ds_read_b128 v[156:159], v2 offset:5120
  v_mfma_f32_16x16x32_bf16 v[208:211], v[40:43], v[68:71], v[208:211]
  ds_read_b128 v[168:171], v2 offset:6144
  ds_read_b128 v[172:175], v2 offset:7168
  v_mfma_f32_16x16x32_bf16 v[212:215], v[40:43], v[72:75], v[212:215]
  ds_read_b128 v[184:187], v2 offset:8192
  ds_read_b128 v[188:191], v2 offset:9216
  v_mfma_f32_16x16x32_bf16 v[224:227], v[44:47], v[68:71], v[224:227]
  ds_read_b128 v[200:203], v2 offset:10240
  ds_read_b128 v[204:207], v2 offset:11264
  v_mfma_f32_16x16x32_bf16 v[228:231], v[44:47], v[72:75], v[228:231]
  ds_read_b128 v[216:219], v2 offset:12288
  ds_read_b128 v[220:223], v2 offset:13312
  v_mfma_f32_16x16x32_bf16 v[240:243], v[48:51], v[68:71], v[240:243]
  ds_read_b128 v[232:235], v2 offset:14336
  ds_read_b128 v[236:239], v2 offset:15360
  v_mfma_f32_16x16x32_bf16 v[244:247], v[48:51], v[72:75], v[244:247]
  ds_read_b128 v[248:251], v2 offset:16384
  ds_read_b128 v[252:255], v2 offset:17408
  s_waitcnt lgkmcnt(15)
  v_pk_add_f32 v[112:113], v[112:113], v[120:121]
  v_pk_add_f32 v[114:115], v[114:115], v[122:123]
  s_waitcnt lgkmcnt(15)
  v_pk_add_f32 v[116:117], v[116:117], v[124:125]
  v_pk_add_f32 v[118:119], v[118:119], v[126:127]
  s_waitcnt lgkmcnt(15)
  v_pk_add_f32 v[128:129], v[128:129], v[136:137]
  v_pk_add_f32 v[130:131], v[130:131], v[138:139]
  s_waitcnt lgkmcnt(14)
  v_pk_add_f32 v[132:133], v[132:133], v[140:141]
  v_pk_add_f32 v[134:135], v[134:135], v[142:143]
  s_waitcnt lgkmcnt(13)
  v_pk_add_f32 v[144:145], v[144:145], v[152:153]
  v_pk_add_f32 v[146:147], v[146:147], v[154:155]
  s_waitcnt lgkmcnt(12)
  v_pk_add_f32 v[148:149], v[148:149], v[156:157]
  v_pk_add_f32 v[150:151], v[150:151], v[158:159]
  s_waitcnt lgkmcnt(11)
  v_pk_add_f32 v[160:161], v[160:161], v[168:169]
  v_pk_add_f32 v[162:163], v[162:163], v[170:171]
  s_waitcnt lgkmcnt(10)
  v_pk_add_f32 v[164:165], v[164:165], v[172:173]
  v_pk_add_f32 v[166:167], v[166:167], v[174:175]
  s_waitcnt lgkmcnt(9)
  v_pk_add_f32 v[176:177], v[176:177], v[184:185]
  v_pk_add_f32 v[178:179], v[178:179], v[186:187]
  s_waitcnt lgkmcnt(8)
  v_pk_add_f32 v[180:181], v[180:181], v[188:189]
  v_pk_add_f32 v[182:183], v[182:183], v[190:191]
  s_waitcnt lgkmcnt(7)
  v_pk_add_f32 v[192:193], v[192:193], v[200:201]
  v_pk_add_f32 v[194:195], v[194:195], v[202:203]
  s_waitcnt lgkmcnt(6)
  v_pk_add_f32 v[196:197], v[196:197], v[204:205]
  v_pk_add_f32 v[198:199], v[198:199], v[206:207]
  s_waitcnt lgkmcnt(5)
  v_pk_add_f32 v[208:209], v[208:209], v[216:217]
  v_pk_add_f32 v[210:211], v[210:211], v[218:219]
  s_waitcnt lgkmcnt(4)
  v_pk_add_f32 v[212:213], v[212:213], v[220:221]
  v_pk_add_f32 v[214:215], v[214:215], v[222:223]
  s_waitcnt lgkmcnt(3)
  v_pk_add_f32 v[224:225], v[224:225], v[232:233]
  v_pk_add_f32 v[226:227], v[226:227], v[234:235]
  s_waitcnt lgkmcnt(2)
  v_pk_add_f32 v[228:229], v[228:229], v[236:237]
  v_pk_add_f32 v[230:231], v[230:231], v[238:239]
  s_waitcnt lgkmcnt(1)
  s_nop 7
  v_pk_add_f32 v[240:241], v[240:241], v[248:249]
  v_pk_add_f32 v[242:243], v[242:243], v[250:251]
  s_waitcnt lgkmcnt(0)
  v_pk_add_f32 v[244:245], v[244:245], v[252:253]
  v_pk_add_f32 v[246:247], v[246:247], v[254:255]
  s_cmp_eq_u32 s43, s41
  s_cbranch_scc1 L_p3_own
  s_lshl_b32 s52, s40, 2
  s_add_u32 s52, s52, s42
  s_lshl_b32 s52, s52, 2
  s_add_u32 s52, s52, s43
  s_lshl_b32 s52, s52, 2
  s_add_u32 s52, s52, s41
  s_mul_i32 s52, s52, 18432
  s_add_u32 s52, s52, 33554432
  v_cvt_pk_bf16_f32 v120, v112, v113
  v_cvt_pk_bf16_f32 v121, v114, v115
  v_cvt_pk_bf16_f32 v122, v116, v117
  v_cvt_pk_bf16_f32 v123, v118, v119
  buffer_store_dwordx4 v[120:123], v10, s[36:39], s52 offen offset:0 sc1
  v_cvt_pk_bf16_f32 v136, v128, v129
  v_cvt_pk_bf16_f32 v137, v130, v131
  v_cvt_pk_bf16_f32 v138, v132, v133
  v_cvt_pk_bf16_f32 v139, v134, v135
  buffer_store_dwordx4 v[136:139], v10, s[36:39], s52 offen offset:1024 sc1
  v_cvt_pk_bf16_f32 v152, v144, v145
  v_cvt_pk_bf16_f32 v153, v146, v147
  v_cvt_pk_bf16_f32 v154, v148, v149
  v_cvt_pk_bf16_f32 v155, v150, v151
  buffer_store_dwordx4 v[152:155], v10, s[36:39], s52 offen offset:2048 sc1
  v_cvt_pk_bf16_f32 v168, v160, v161
  v_cvt_pk_bf16_f32 v169, v162, v163
  v_cvt_pk_bf16_f32 v170, v164, v165
  v_cvt_pk_bf16_f32 v171, v166, v167
  buffer_store_dwordx4 v[168:171], v10, s[36:39], s52 offen offset:3072 sc1
  v_cvt_pk_bf16_f32 v184, v176, v177
  v_cvt_pk_bf16_f32 v185, v178, v179
  v_cvt_pk_bf16_f32 v186, v180, v181
  v_cvt_pk_bf16_f32 v187, v182, v183
  s_add_u32 s52, s52, 4096
  buffer_store_dwordx4 v[184:187], v10, s[36:39], s52 offen offset:0 sc1
  v_cvt_pk_bf16_f32 v200, v192, v193
  v_cvt_pk_bf16_f32 v201, v194, v195
  v_cvt_pk_bf16_f32 v202, v196, v197
  v_cvt_pk_bf16_f32 v203, v198, v199
  buffer_store_dwordx4 v[200:203], v10, s[36:39], s52 offen offset:1024 sc1
  v_cvt_pk_bf16_f32 v216, v208, v209
  v_cvt_pk_bf16_f32 v217, v210, v211
  v_cvt_pk_bf16_f32 v218, v212, v213
  v_cvt_pk_bf16_f32 v219, v214, v215
  buffer_store_dwordx4 v[216:219], v10, s[36:39], s52 offen offset:2048 sc1
  v_cvt_pk_bf16_f32 v232, v224, v225
  v_cvt_pk_bf16_f32 v233, v226, v227
  v_cvt_pk_bf16_f32 v234, v228, v229
  v_cvt_pk_bf16_f32 v235, v230, v231
  buffer_store_dwordx4 v[232:235], v10, s[36:39], s52 offen offset:3072 sc1
  v_cvt_pk_bf16_f32 v248, v240, v241
  v_cvt_pk_bf16_f32 v249, v242, v243
  v_cvt_pk_bf16_f32 v250, v244, v245
  v_cvt_pk_bf16_f32 v251, v246, v247
  s_add_u32 s52, s52, 4096
  buffer_store_dwordx4 v[248:251], v10, s[36:39], s52 offen offset:0 sc1
  s_lshl_b32 s52, s40, 2
  s_add_u32 s52, s52, s43
  s_lshl_b32 s52, s52, 2
  s_add_u32 s52, s52, s42
  s_lshl_b32 s52, s52, 7
  s_lshl_b32 s53, s41, 2
  s_add_u32 s52, s52, s53
  s_add_u32 s52, s52, 67108880
  v_mov_b32 v1, 0
  v_mov_b32 v2, 1
  s_barrier
  s_waitcnt vmcnt(0)
  s_mov_b64 exec, 1
  buffer_store_dword v2, v1, s[36:39], s52 offen sc1
  s_mov_b64 exec, -1
  s_branch L_tail
L_p3_own:
  ds_write_b128 v3, v[112:115] offset:0
  ds_write_b128 v3, v[116:119] offset:1024
  ds_write_b128 v3, v[128:131] offset:2048
  ds_write_b128 v3, v[132:135] offset:3072
  ds_write_b128 v3, v[144:147] offset:4096
  ds_write_b128 v3, v[148:151] offset:5120
  ds_write_b128 v3, v[160:163] offset:6144
  ds_write_b128 v3, v[164:167] offset:7168
  ds_write_b128 v3, v[176:179] offset:8192
  ds_write_b128 v3, v[180:183] offset:9216
  ds_write_b128 v3, v[192:195] offset:10240
  ds_write_b128 v3, v[196:199] offset:11264
  ds_write_b128 v3, v[208:211] offset:12288
  ds_write_b128 v3, v[212:215] offset:13312
  ds_write_b128 v3, v[224:227] offset:14336
  ds_write_b128 v3, v[228:231] offset:15360
  ds_write_b128 v3, v[240:243] offset:16384
  ds_write_b128 v3, v[244:247] offset:17408
  s_waitcnt lgkmcnt(0)
  s_barrier
  s_branch L_tail
L_tail:
  v_and_b32 v25, 15, v0
  v_lshlrev_b32 v25, 2, v25
  s_lshl_b32 s52, s40, 2
  s_add_u32 s52, s52, s42
  s_lshl_b32 s52, s52, 2
  s_add_u32 s52, s52, s41
  s_mul_i32 s52, s52, 73728
  s_add_u32 s52, s52, 33554432
  s_mul_i32 s53, s43, 1024
  s_add_u32 s52, s52, s53
  s_add_u32 s54, s41, 1
  s_and_b32 s54, s54, 3
  s_mul_i32 s54, s54, 18432
  s_add_u32 s56, s52, s54
  s_add_u32 s54, s41, 2
  s_and_b32 s54, s54, 3
  s_mul_i32 s54, s54, 18432
  s_add_u32 s57, s52, s54
  s_add_u32 s54, s41, 3
  s_and_b32 s54, s54, 3
  s_mul_i32 s54, s54, 18432
  s_add_u32 s58, s52, s54
  s_lshl_b32 s53, s43, 11
  s_add_u32 s54, s53, 101376
  v_add_u32 v1, s54, v10
  v_and_b32 v2, 15, v0
  v_mul_u32_u24 v2, 1152, v2
  v_lshrrev_b32 v3, 4, v0
  v_lshl_add_u32 v2, v3, 3, v2
  s_lshl_b32 s54, s40, 2
  s_add_u32 s54, s54, s41
  s_mul_i32 s54, s54, 36864
  s_mul_i32 s55, s42, 288
  s_add_u32 s59, s54, s55
  s_lshl_b32 s55, s43, 5
  s_add_u32 s59, s59, s55
  s_lshl_b32 s61, 16, s41
  s_xor_b32 s61, s61, 0xf0
  ds_read_b128 v[32:35], v1 offset:0
  ds_read_b128 v[36:39], v1 offset:1024
  s_cmp_lg_u32 s43, 0
  s_cbranch_scc1 L_tail_a
  ds_read_b128 v[64:67], v1 offset:16384
  ds_read_b128 v[68:71], v1 offset:17408
L_tail_a:
  s_mov_b32 s63, 400000
L_poll_tail:
  buffer_load_dword v24, v25, s[36:39], s96 offen sc1
  s_waitcnt vmcnt(0)
  v_cmp_le_u32 vcc, 1, v24
  s_sub_u32 s63, s63, 1
  s_cmp_eq_u32 s63, 0
  s_cbranch_scc1 L_polld_tail
  s_and_b32 s64, vcc_lo, s61
  s_cmp_eq_u32 s64, s61
  s_cbranch_scc1 L_polld_tail
  s_sleep 1
  s_branch L_poll_tail
L_polld_tail:
  buffer_load_dwordx4 v[40:43], v10, s[36:39], s56 offen sc1
  buffer_load_dwordx4 v[48:51], v10, s[36:39], s57 offen sc1
  buffer_load_dwordx4 v[56:59], v10, s[36:39], s58 offen sc1
  s_cmp_lg_u32 s43, 0
  s_cbranch_scc1 L_tail_b
  s_add_u32 s56, s56, 8192
  buffer_load_dwordx4 v[72:75], v10, s[36:39], s56 offen sc1
  s_add_u32 s57, s57, 8192
  buffer_load_dwordx4 v[80:83], v10, s[36:39], s57 offen sc1
  s_add_u32 s58, s58, 8192
  buffer_load_dwordx4 v[88:91], v10, s[36:39], s58 offen sc1
  s_waitcnt vmcnt(0) lgkmcnt(0)
  v_and_b32 v47, 0xffff0000, v43
  v_lshlrev_b32 v46, 16, v43
  v_and_b32 v45, 0xffff0000, v42
  v_lshlrev_b32 v44, 16, v42
  v_and_b32 v43, 0xffff0000, v41
  v_lshlrev_b32 v42, 16, v41
  v_and_b32 v41, 0xffff0000, v40
  v_lshlrev_b32 v40, 16, v40
  v_pk_add_f32 v[32:33], v[32:33], v[40:41]
  v_pk_add_f32 v[34:35], v[34:35], v[42:43]
  v_pk_add_f32 v[36:37], v[36:37], v[44:45]
  v_pk_add_f32 v[38:39], v[38:39], v[46:47]
  v_and_b32 v55, 0xffff0000, v51
  v_lshlrev_b32 v54, 16, v51
  v_and_b32 v53, 0xffff0000, v50
  v_lshlrev_b32 v52, 16, v50
  v_and_b32 v51, 0xffff0000, v49
  v_lshlrev_b32 v50, 16, v49
  v_and_b32 v49, 0xffff0000, v48
  v_lshlrev_b32 v48, 16, v48
  v_pk_add_f32 v[32:33], v[32:33], v[48:49]
  v_pk_add_f32 v[34:35], v[34:35], v[50:51]
  v_pk_add_f32 v[36:37], v[36:37], v[52:53]
  v_pk_add_f32 v[38:39], v[38:39], v[54:55]
  v_and_b32 v63, 0xffff0000, v59
  v_lshlrev_b32 v62, 16, v59
  v_and_b32 v61, 0xffff0000, v58
  v_lshlrev_b32 v60, 16, v58
  v_and_b32 v59, 0xffff0000, v57
  v_lshlrev_b32 v58, 16, v57
  v_and_b32 v57, 0xffff0000, v56
  v_lshlrev_b32 v56, 16, v56
  v_pk_add_f32 v[32:33], v[32:33], v[56:57]
  v_pk_add_f32 v[34:35], v[34:35], v[58:59]
  v_pk_add_f32 v[36:37], v[36:37], v[60:61]
  v_pk_add_f32 v[38:39], v[38:39], v[62:63]
  v_cvt_pk_bf16_f32 v40, v32, v33
  v_cvt_pk_bf16_f32 v41, v34, v35
  v_cvt_pk_bf16_f32 v42, v36, v37
  v_cvt_pk_bf16_f32 v43, v38, v39
  buffer_store_dwordx2 v[40:41], v2, s[28:31], s59 offen
  s_add_u32 s54, s59, 18432
  buffer_store_dwordx2 v[42:43], v2, s[28:31], s54 offen
  v_and_b32 v79, 0xffff0000, v75
  v_lshlrev_b32 v78, 16, v75
  v_and_b32 v77, 0xffff0000, v74
  v_lshlrev_b32 v76, 16, v74
  v_and_b32 v75, 0xffff0000, v73
  v_lshlrev_b32 v74, 16, v73
  v_and_b32 v73, 0xffff0000, v72
  v_lshlrev_b32 v72, 16, v72
  v_pk_add_f32 v[64:65], v[64:65], v[72:73]
  v_pk_add_f32 v[66:67], v[66:67], v[74:75]
  v_pk_add_f32 v[68:69], v[68:69], v[76:77]
  v_pk_add_f32 v[70:71], v[70:71], v[78:79]
  v_and_b32 v87, 0xffff0000, v83
  v_lshlrev_b32 v86, 16, v83
  v_and_b32 v85, 0xffff0000, v82
  v_lshlrev_b32 v84, 16, v82
  v_and_b32 v83, 0xffff0000, v81
  v_lshlrev_b32 v82, 16, v81
  v_and_b32 v81, 0xffff0000, v80
  v_lshlrev_b32 v80, 16, v80
  v_pk_add_f32 v[64:65], v[64:65], v[80:81]
  v_pk_add_f32 v[66:67], v[66:67], v[82:83]
  v_pk_add_f32 v[68:69], v[68:69], v[84:85]
  v_pk_add_f32 v[70:71], v[70:71], v[86:87]
  v_and_b32 v95, 0xffff0000, v91
  v_lshlrev_b32 v94, 16, v91
  v_and_b32 v93, 0xffff0000, v90
  v_lshlrev_b32 v92, 16, v90
  v_and_b32 v91, 0xffff0000, v89
  v_lshlrev_b32 v90, 16, v89
  v_and_b32 v89, 0xffff0000, v88
  v_lshlrev_b32 v88, 16, v88
  v_pk_add_f32 v[64:65], v[64:65], v[88:89]
  v_pk_add_f32 v[66:67], v[66:67], v[90:91]
  v_pk_add_f32 v[68:69], v[68:69], v[92:93]
  v_pk_add_f32 v[70:71], v[70:71], v[94:95]
  v_cvt_pk_bf16_f32 v72, v64, v65
  v_cvt_pk_bf16_f32 v73, v66, v67
  v_cvt_pk_bf16_f32 v74, v68, v69
  v_cvt_pk_bf16_f32 v75, v70, v71
  s_add_u32 s59, s59, 256
  buffer_store_dwordx2 v[72:73], v2, s[28:31], s59 offen
  s_add_u32 s54, s59, 18432
  buffer_store_dwordx2 v[74:75], v2, s[28:31], s54 offen
  s_branch L_tail2
L_tail_b:
  s_waitcnt vmcnt(0) lgkmcnt(0)
  v_and_b32 v47, 0xffff0000, v43
  v_lshlrev_b32 v46, 16, v43
  v_and_b32 v45, 0xffff0000, v42
  v_lshlrev_b32 v44, 16, v42
  v_and_b32 v43, 0xffff0000, v41
  v_lshlrev_b32 v42, 16, v41
  v_and_b32 v41, 0xffff0000, v40
  v_lshlrev_b32 v40, 16, v40
  v_pk_add_f32 v[32:33], v[32:33], v[40:41]
  v_pk_add_f32 v[34:35], v[34:35], v[42:43]
  v_pk_add_f32 v[36:37], v[36:37], v[44:45]
  v_pk_add_f32 v[38:39], v[38:39], v[46:47]
  v_and_b32 v55, 0xffff0000, v51
  v_lshlrev_b32 v54, 16, v51
  v_and_b32 v53, 0xffff0000, v50
  v_lshlrev_b32 v52, 16, v50
  v_and_b32 v51, 0xffff0000, v49
  v_lshlrev_b32 v50, 16, v49
  v_and_b32 v49, 0xffff0000, v48
  v_lshlrev_b32 v48, 16, v48
  v_pk_add_f32 v[32:33], v[32:33], v[48:49]
  v_pk_add_f32 v[34:35], v[34:35], v[50:51]
  v_pk_add_f32 v[36:37], v[36:37], v[52:53]
  v_pk_add_f32 v[38:39], v[38:39], v[54:55]
  v_and_b32 v63, 0xffff0000, v59
  v_lshlrev_b32 v62, 16, v59
  v_and_b32 v61, 0xffff0000, v58
  v_lshlrev_b32 v60, 16, v58
  v_and_b32 v59, 0xffff0000, v57
  v_lshlrev_b32 v58, 16, v57
  v_and_b32 v57, 0xffff0000, v56
  v_lshlrev_b32 v56, 16, v56
  v_pk_add_f32 v[32:33], v[32:33], v[56:57]
  v_pk_add_f32 v[34:35], v[34:35], v[58:59]
  v_pk_add_f32 v[36:37], v[36:37], v[60:61]
  v_pk_add_f32 v[38:39], v[38:39], v[62:63]
  v_cvt_pk_bf16_f32 v40, v32, v33
  v_cvt_pk_bf16_f32 v41, v34, v35
  v_cvt_pk_bf16_f32 v42, v36, v37
  v_cvt_pk_bf16_f32 v43, v38, v39
  buffer_store_dwordx2 v[40:41], v2, s[28:31], s59 offen
  s_add_u32 s54, s59, 18432
  buffer_store_dwordx2 v[42:43], v2, s[28:31], s54 offen
L_tail2:
L_end:
  s_endpgm
.section .rodata,"a"
.p2align 6
.amdhsa_kernel standalone__dense_activation_silu__prompt_kernel
  .amdhsa_next_free_vgpr 256
  .amdhsa_next_free_sgpr 100
  .amdhsa_accum_offset 256
  .amdhsa_group_segment_fixed_size 0
  .amdhsa_kernarg_size 48
  .amdhsa_user_sgpr_count 2
  .amdhsa_user_sgpr_kernarg_segment_ptr 1
  .amdhsa_system_sgpr_workgroup_id_x 1
.end_amdhsa_kernel
```
